```python
import torch

def _softmax(x, axis=-1):
    return torch.softmax(x, dim=axis)
def _gelu(x):
    return torch.nn.functional.gelu(x, approximate="tanh")
def _silu(x):
    return torch.nn.functional.silu(x)
def _sigmoid(x):
    return torch.sigmoid(x)
def _layernorm(x, axis=-1, eps=1e-5):
    m = x.mean(dim=axis, keepdim=True)
    v = x.var(dim=axis, keepdim=True, unbiased=False)
    return (x - m) / torch.sqrt(v + eps)
def _scatter_add(tgt, idx, src, axis=0):
    return tgt.clone().index_add_(axis, idx, src)
def _segment_sum(src, seg, n):
    out = torch.zeros((n,) + src.shape[1:], dtype=src.dtype)
    return out.index_add_(0, seg, src)
def _pad(x, pw):
    flat = tuple(v for pair in reversed(pw) for v in pair)
    return torch.nn.functional.pad(x, flat)

kernel_name = 'recurrent_scan__gqa_block_cached__geglu_ffn__decode'

def setup_inputs():

    _w = (lambda a: (lambda t: t.to(torch.bfloat16) if t.is_floating_point() else t)(torch.as_tensor(a)))
    def _A_setup():
        B, Sq, D = 4, 1, 640
        Hq, Hkv, Sk, Dh = 32, 32, 4096, 128
        assert Hq % Hkv == 0, (Hq, Hkv)
        return {
            "x": _w((lambda *s: torch.randn(*s, dtype=torch.bfloat16) * 0.05)(B, Sq, D)),
            "k_cache": _w((lambda *s: torch.randn(*s, dtype=torch.bfloat16) * 1.6)(B, Hkv, Sk, Dh)),
            "v_cache": _w((lambda *s: torch.randn(*s, dtype=torch.bfloat16) * 0.2)(B, Hkv, Sk, Dh)),
            "wq": _w((lambda *s: torch.randn(*s, dtype=torch.bfloat16) * 1.6)(D, Hq * Dh) * (D ** -0.5)),
            "wo": _w((lambda *s: torch.randn(*s, dtype=torch.bfloat16) * 0.2)(Hq * Dh, D) * ((Hq * Dh) ** -0.5)),
        }
    _A_in = _A_setup()

    def _B_setup():
        B, S, D, F = 4, 1, 640, 1728
        return {
            "x": _w((lambda *s: torch.randn(*s, dtype=torch.bfloat16) * 0.05)(B, S, D)),
            "w_gate": _w((lambda *s: torch.randn(*s, dtype=torch.bfloat16) * 0.1)(D, F)),
            "w_up": _w((lambda *s: torch.randn(*s, dtype=torch.bfloat16) * 0.1)(D, F)),
            "w_down": _w((lambda *s: torch.randn(*s, dtype=torch.bfloat16) * 0.1)(F, D)),
        }
    _B_in = _B_setup()

    return {
        "A_x": _A_in["x"],
        "A_k_cache": _A_in["k_cache"],
        "A_v_cache": _A_in["v_cache"],
        "A_wq": _A_in["wq"],
        "A_wo": _A_in["wo"],
        "B_x": _B_in["x"],
        "B_w_gate": _B_in["w_gate"],
        "B_w_up": _B_in["w_up"],
        "B_w_down": _B_in["w_down"],
    }

def reference(A_x, A_k_cache, A_v_cache, A_wq, A_wo, B_x, B_w_gate, B_w_up, B_w_down):
    def _A_ref(x, k_cache, v_cache, wq, wo):
        B, Sq, D = x.shape
        Hq, Dh = 32, 128
        Hkv = k_cache.shape[1]
        rep = Hq // Hkv
        q = (lambda x, *d: x.permute(*d))((x @ wq).reshape(B, Sq, Hq, Dh), 0, 2, 1, 3)
        k = (lambda x, n, axis: torch.repeat_interleave(x, n, dim=axis))(k_cache, rep, axis=1)
        v = (lambda x, n, axis: torch.repeat_interleave(x, n, dim=axis))(v_cache, rep, axis=1)
        scores = torch.einsum("bhqd,bhkd->bhqk", q, k) * (Dh ** -0.5)
        p = _softmax(scores, axis=-1)
        o = torch.einsum("bhqk,bhkd->bhqd", p, v)
        return (lambda x, *d: x.permute(*d))(o, 0, 2, 1, 3).reshape(B, Sq, Hq * Dh) @ wo

    def _B_ref(x, w_gate, w_up, w_down):
        return (_gelu(x @ w_gate) * (x @ w_up)) @ w_down

    x = A_x
    xn = _layernorm(x, axis=-1)
    s = _A_ref(xn, A_k_cache, A_v_cache, A_wq, A_wo)
    g = _silu(_B_ref(xn, B_w_gate, B_w_up, B_w_down))
    return x + s * g
```

```asm
; @launch grid=(256,1,1) block=(512,1,1) lds=96768
.amdgcn_target "amdgcn-amd-amdhsa--gfx950"
.text
.globl recurrent_scan__gqa_block_cached__geglu_ffn__decode_kernel
.p2align 8
.type recurrent_scan__gqa_block_cached__geglu_ffn__decode_kernel,@function
recurrent_scan__gqa_block_cached__geglu_ffn__decode_kernel:
  s_cmp_ge_u32 s2, 256
  s_cbranch_scc1 L_exit
  s_load_dwordx16 s[4:19], s[0:1], 0
  s_load_dwordx8 s[20:27], s[0:1], 64
  v_lshrrev_b32 v2, 6, v0
  v_and_b32 v1, 63, v0
  v_readfirstlane_b32 s28, v2
  s_and_b32 s29, s2, 7
  s_lshl_b32 s29, s29, 2
  s_bfe_u32 s49, s2, 0x20004
  s_or_b32 s29, s29, s49
  s_bfe_u32 s30, s2, 0x10003
  s_lshr_b32 s31, s2, 6
  s_lshl_b32 s32, s31, 1
  s_or_b32 s32, s32, s30
  s_and_b32 s33, s28, 3
  s_cmp_ge_u32 s28, 4
  s_cbranch_scc1 L_service
  s_lshl_b32 s49, s31, 5
  s_add_u32 s49, s49, s29
  s_lshl_b32 s49, s49, 1
  s_add_u32 s49, s49, s30
  s_lshl_b32 s49, s49, 19
  s_lshl_b32 s50, s33, 12
  v_lshlrev_b32 v2, 4, v1
  v_add_u32 v2, s50, v2
  s_waitcnt lgkmcnt(0)
  s_add_u32 s36, s6, s49
  s_addc_u32 s37, s7, 0
  s_mov_b32 s38, 524288
  s_mov_b32 s39, 0x20000
  s_add_u32 s40, s8, s49
  s_addc_u32 s41, s9, 0
  s_mov_b32 s42, 524288
  s_mov_b32 s43, 0x20000
  s_mov_b32 s48, 0
  buffer_load_dwordx4 v[80:83], v2, s[36:39], s48 offen offset:0 nt
  buffer_load_dwordx4 v[84:87], v2, s[36:39], s48 offen offset:1024 nt
  buffer_load_dwordx4 v[88:91], v2, s[36:39], s48 offen offset:2048 nt
  buffer_load_dwordx4 v[92:95], v2, s[36:39], s48 offen offset:3072 nt
  s_mov_b32 s48, 16384
  buffer_load_dwordx4 v[96:99], v2, s[36:39], s48 offen offset:0 nt
  s_barrier
  v_and_b32 v76, 15, v1
  v_lshrrev_b32 v77, 1, v76
  v_and_b32 v78, 1, v76
  v_mov_b32 v79, 0xffff
  v_lshlrev_b32 v78, 4, v78
  v_lshlrev_b32 v79, v78, v79
  v_cmp_eq_u32 vcc, 0, v77
  s_nop 1
  v_cndmask_b32 v8, 0, v79, vcc
  v_cmp_eq_u32 vcc, 1, v77
  s_nop 1
  v_cndmask_b32 v9, 0, v79, vcc
  v_cmp_eq_u32 vcc, 2, v77
  s_nop 1
  v_cndmask_b32 v10, 0, v79, vcc
  v_cmp_eq_u32 vcc, 3, v77
  s_nop 1
  v_cndmask_b32 v11, 0, v79, vcc
  v_mov_b32 v12, 0
  v_mov_b32 v13, 0
  v_mov_b32 v14, 0
  v_mov_b32 v15, 0
  v_mov_b32 v72, 0xff800000
  v_mov_b32 v73, 0
  s_mov_b32 s54, 0x3fb8aa3b
  v_lshlrev_b32 v76, 4, v76
  v_add_u32 v76, 13312, v76
  s_waitcnt vmcnt(4)
  buffer_load_dwordx4 v[100:103], v2, s[36:39], s48 offen offset:1024 nt
  s_waitcnt vmcnt(4)
  buffer_load_dwordx4 v[104:107], v2, s[36:39], s48 offen offset:2048 nt
  s_waitcnt vmcnt(4)
  buffer_load_dwordx4 v[108:111], v2, s[36:39], s48 offen offset:3072 nt
  s_waitcnt vmcnt(4)
  s_mov_b32 s48, 32768
  buffer_load_dwordx4 v[112:115], v2, s[36:39], s48 offen offset:0 nt
  s_waitcnt vmcnt(4)
  buffer_load_dwordx4 v[116:119], v2, s[36:39], s48 offen offset:1024 nt
  s_waitcnt vmcnt(4)
  buffer_load_dwordx4 v[120:123], v2, s[36:39], s48 offen offset:2048 nt
  s_waitcnt vmcnt(4)
  buffer_load_dwordx4 v[124:127], v2, s[36:39], s48 offen offset:3072 nt
  s_waitcnt vmcnt(4)
  s_mov_b32 s48, 49152
  buffer_load_dwordx4 v[128:131], v2, s[36:39], s48 offen offset:0 nt
  s_waitcnt vmcnt(4)
  buffer_load_dwordx4 v[132:135], v2, s[36:39], s48 offen offset:1024 nt
  s_waitcnt vmcnt(4)
  buffer_load_dwordx4 v[136:139], v2, s[36:39], s48 offen offset:2048 nt
  s_waitcnt vmcnt(4)
  buffer_load_dwordx4 v[140:143], v2, s[36:39], s48 offen offset:3072 nt
  s_waitcnt vmcnt(4)
  s_mov_b32 s48, 65536
  buffer_load_dwordx4 v[144:147], v2, s[36:39], s48 offen offset:0 nt
  s_waitcnt vmcnt(4)
  buffer_load_dwordx4 v[148:151], v2, s[36:39], s48 offen offset:1024 nt
  s_waitcnt vmcnt(4)
  buffer_load_dwordx4 v[152:155], v2, s[36:39], s48 offen offset:2048 nt
  s_waitcnt vmcnt(4)
  buffer_load_dwordx4 v[156:159], v2, s[36:39], s48 offen offset:3072 nt
  s_waitcnt vmcnt(4)
  s_mov_b32 s48, 81920
  buffer_load_dwordx4 v[160:163], v2, s[36:39], s48 offen offset:0 nt
  s_waitcnt vmcnt(4)
  buffer_load_dwordx4 v[164:167], v2, s[36:39], s48 offen offset:1024 nt
  s_waitcnt vmcnt(4)
  buffer_load_dwordx4 v[168:171], v2, s[36:39], s48 offen offset:2048 nt
  s_waitcnt vmcnt(4)
  buffer_load_dwordx4 v[172:175], v2, s[36:39], s48 offen offset:3072 nt
  s_waitcnt vmcnt(4)
  s_mov_b32 s48, 98304
  buffer_load_dwordx4 v[176:179], v2, s[36:39], s48 offen offset:0 nt
  s_waitcnt vmcnt(4)
  buffer_load_dwordx4 v[180:183], v2, s[36:39], s48 offen offset:1024 nt
  s_waitcnt vmcnt(4)
  buffer_load_dwordx4 v[184:187], v2, s[36:39], s48 offen offset:2048 nt
  s_waitcnt vmcnt(4)
  buffer_load_dwordx4 v[188:191], v2, s[36:39], s48 offen offset:3072 nt
  s_waitcnt vmcnt(4)
  s_mov_b32 s48, 114688
  buffer_load_dwordx4 v[192:195], v2, s[36:39], s48 offen offset:0 nt
  s_waitcnt vmcnt(4)
  buffer_load_dwordx4 v[196:199], v2, s[36:39], s48 offen offset:1024 nt
  s_waitcnt vmcnt(4)
  buffer_load_dwordx4 v[200:203], v2, s[36:39], s48 offen offset:2048 nt
  s_waitcnt vmcnt(4)
  buffer_load_dwordx4 v[204:207], v2, s[36:39], s48 offen offset:3072 nt
  s_waitcnt vmcnt(4)
  s_mov_b32 s48, 131072
  buffer_load_dwordx4 v[208:211], v2, s[36:39], s48 offen offset:0 nt
  s_waitcnt vmcnt(4)
  buffer_load_dwordx4 v[212:215], v2, s[36:39], s48 offen offset:1024 nt
  s_waitcnt vmcnt(4)
  buffer_load_dwordx4 v[216:219], v2, s[36:39], s48 offen offset:2048 nt
  s_waitcnt vmcnt(4)
  buffer_load_dwordx4 v[220:223], v2, s[36:39], s48 offen offset:3072 nt
  s_waitcnt vmcnt(4)
  s_mov_b32 s48, 147456
  buffer_load_dwordx4 v[224:227], v2, s[36:39], s48 offen offset:0 nt
  s_waitcnt vmcnt(4)
  buffer_load_dwordx4 v[228:231], v2, s[36:39], s48 offen offset:1024 nt
  s_waitcnt vmcnt(4)
  buffer_load_dwordx4 v[232:235], v2, s[36:39], s48 offen offset:2048 nt
  s_waitcnt vmcnt(4)
  buffer_load_dwordx4 v[236:239], v2, s[36:39], s48 offen offset:3072 nt
  s_waitcnt vmcnt(4)
  s_mov_b32 s48, 163840
  buffer_load_dwordx4 v[240:243], v2, s[36:39], s48 offen offset:0 nt
  s_waitcnt vmcnt(4)
  buffer_load_dwordx4 v[244:247], v2, s[36:39], s48 offen offset:1024 nt
  s_waitcnt vmcnt(4)
  buffer_load_dwordx4 v[248:251], v2, s[36:39], s48 offen offset:2048 nt
  s_waitcnt vmcnt(4)
  buffer_load_dwordx4 v[252:255], v2, s[36:39], s48 offen offset:3072 nt
  s_barrier
  ds_read_b128 v[4:7], v76
  s_waitcnt lgkmcnt(0)
  v_dot2_f32_bf16 v16, v80, v4, 0
  v_dot2_f32_bf16 v16, v81, v5, v16
  v_dot2_f32_bf16 v16, v82, v6, v16
  v_dot2_f32_bf16 v16, v83, v7, v16
  s_mov_b32 s48, 180224
  buffer_load_dwordx4 v[80:83], v2, s[36:39], s48 offen offset:0 nt
  v_dot2_f32_bf16 v17, v84, v4, 0
  v_dot2_f32_bf16 v17, v85, v5, v17
  v_dot2_f32_bf16 v17, v86, v6, v17
  v_dot2_f32_bf16 v17, v87, v7, v17
  buffer_load_dwordx4 v[84:87], v2, s[36:39], s48 offen offset:1024 nt
  v_dot2_f32_bf16 v18, v88, v4, 0
  v_dot2_f32_bf16 v18, v89, v5, v18
  v_dot2_f32_bf16 v18, v90, v6, v18
  v_dot2_f32_bf16 v18, v91, v7, v18
  buffer_load_dwordx4 v[88:91], v2, s[36:39], s48 offen offset:2048 nt
  v_dot2_f32_bf16 v19, v92, v4, 0
  v_dot2_f32_bf16 v19, v93, v5, v19
  v_dot2_f32_bf16 v19, v94, v6, v19
  v_dot2_f32_bf16 v19, v95, v7, v19
  buffer_load_dwordx4 v[92:95], v2, s[36:39], s48 offen offset:3072 nt
  v_dot2_f32_bf16 v20, v96, v4, 0
  v_dot2_f32_bf16 v20, v97, v5, v20
  v_dot2_f32_bf16 v20, v98, v6, v20
  v_dot2_f32_bf16 v20, v99, v7, v20
  s_mov_b32 s48, 196608
  buffer_load_dwordx4 v[96:99], v2, s[36:39], s48 offen offset:0 nt
  v_dot2_f32_bf16 v21, v100, v4, 0
  v_dot2_f32_bf16 v21, v101, v5, v21
  v_dot2_f32_bf16 v21, v102, v6, v21
  v_dot2_f32_bf16 v21, v103, v7, v21
  v_dot2_f32_bf16 v22, v104, v4, 0
  v_dot2_f32_bf16 v22, v105, v5, v22
  v_dot2_f32_bf16 v22, v106, v6, v22
  v_dot2_f32_bf16 v22, v107, v7, v22
  v_dot2_f32_bf16 v23, v108, v4, 0
  v_dot2_f32_bf16 v23, v109, v5, v23
  v_dot2_f32_bf16 v23, v110, v6, v23
  v_dot2_f32_bf16 v23, v111, v7, v23
  v_dot2_f32_bf16 v24, v112, v4, 0
  v_dot2_f32_bf16 v24, v113, v5, v24
  v_dot2_f32_bf16 v24, v114, v6, v24
  v_dot2_f32_bf16 v24, v115, v7, v24
  v_dot2_f32_bf16 v25, v116, v4, 0
  v_dot2_f32_bf16 v25, v117, v5, v25
  v_dot2_f32_bf16 v25, v118, v6, v25
  v_dot2_f32_bf16 v25, v119, v7, v25
  v_dot2_f32_bf16 v26, v120, v4, 0
  v_dot2_f32_bf16 v26, v121, v5, v26
  v_dot2_f32_bf16 v26, v122, v6, v26
  v_dot2_f32_bf16 v26, v123, v7, v26
  v_dot2_f32_bf16 v27, v124, v4, 0
  v_dot2_f32_bf16 v27, v125, v5, v27
  v_dot2_f32_bf16 v27, v126, v6, v27
  v_dot2_f32_bf16 v27, v127, v7, v27
  v_dot2_f32_bf16 v28, v128, v4, 0
  v_dot2_f32_bf16 v28, v129, v5, v28
  v_dot2_f32_bf16 v28, v130, v6, v28
  v_dot2_f32_bf16 v28, v131, v7, v28
  v_dot2_f32_bf16 v29, v132, v4, 0
  v_dot2_f32_bf16 v29, v133, v5, v29
  v_dot2_f32_bf16 v29, v134, v6, v29
  v_dot2_f32_bf16 v29, v135, v7, v29
  v_dot2_f32_bf16 v30, v136, v4, 0
  v_dot2_f32_bf16 v30, v137, v5, v30
  v_dot2_f32_bf16 v30, v138, v6, v30
  v_dot2_f32_bf16 v30, v139, v7, v30
  v_dot2_f32_bf16 v31, v140, v4, 0
  v_dot2_f32_bf16 v31, v141, v5, v31
  v_dot2_f32_bf16 v31, v142, v6, v31
  v_dot2_f32_bf16 v31, v143, v7, v31
  v_add_f32_dpp v16, v16, v16 row_ror:8 row_mask:0xf bank_mask:0x3
  v_add_f32_dpp v17, v17, v17 row_ror:8 row_mask:0xf bank_mask:0x3
  v_add_f32_dpp v18, v18, v18 row_ror:8 row_mask:0xf bank_mask:0x3
  v_add_f32_dpp v19, v19, v19 row_ror:8 row_mask:0xf bank_mask:0x3
  v_add_f32_dpp v20, v20, v20 row_ror:8 row_mask:0xf bank_mask:0x3
  v_add_f32_dpp v21, v21, v21 row_ror:8 row_mask:0xf bank_mask:0x3
  v_add_f32_dpp v22, v22, v22 row_ror:8 row_mask:0xf bank_mask:0x3
  v_add_f32_dpp v23, v23, v23 row_ror:8 row_mask:0xf bank_mask:0x3
  v_add_f32_dpp v16, v24, v24 row_ror:8 row_mask:0xf bank_mask:0xc
  v_add_f32_dpp v17, v25, v25 row_ror:8 row_mask:0xf bank_mask:0xc
  v_add_f32_dpp v18, v26, v26 row_ror:8 row_mask:0xf bank_mask:0xc
  v_add_f32_dpp v19, v27, v27 row_ror:8 row_mask:0xf bank_mask:0xc
  v_add_f32_dpp v20, v28, v28 row_ror:8 row_mask:0xf bank_mask:0xc
  v_add_f32_dpp v21, v29, v29 row_ror:8 row_mask:0xf bank_mask:0xc
  v_add_f32_dpp v22, v30, v30 row_ror:8 row_mask:0xf bank_mask:0xc
  v_add_f32_dpp v23, v31, v31 row_ror:8 row_mask:0xf bank_mask:0xc
  v_add_f32_dpp v16, v16, v16 row_half_mirror row_mask:0xf bank_mask:0x5
  v_add_f32_dpp v17, v17, v17 row_half_mirror row_mask:0xf bank_mask:0x5
  v_add_f32_dpp v18, v18, v18 row_half_mirror row_mask:0xf bank_mask:0x5
  v_add_f32_dpp v19, v19, v19 row_half_mirror row_mask:0xf bank_mask:0x5
  v_add_f32_dpp v16, v20, v20 row_half_mirror row_mask:0xf bank_mask:0xa
  v_add_f32_dpp v17, v21, v21 row_half_mirror row_mask:0xf bank_mask:0xa
  v_add_f32_dpp v18, v22, v22 row_half_mirror row_mask:0xf bank_mask:0xa
  v_add_f32_dpp v19, v23, v23 row_half_mirror row_mask:0xf bank_mask:0xa
  v_add_f32_dpp v16, v16, v16 quad_perm:[1,0,3,2] row_mask:0xf bank_mask:0xf
  v_add_f32_dpp v17, v17, v17 quad_perm:[1,0,3,2] row_mask:0xf bank_mask:0xf
  v_add_f32_dpp v18, v18, v18 quad_perm:[1,0,3,2] row_mask:0xf bank_mask:0xf
  v_add_f32_dpp v19, v19, v19 quad_perm:[1,0,3,2] row_mask:0xf bank_mask:0xf
  v_add_f32_dpp v32, v16, v16 quad_perm:[2,3,0,1] row_mask:0xf bank_mask:0xf
  v_add_f32_dpp v33, v17, v17 quad_perm:[2,3,0,1] row_mask:0xf bank_mask:0xf
  v_add_f32_dpp v34, v18, v18 quad_perm:[2,3,0,1] row_mask:0xf bank_mask:0xf
  v_add_f32_dpp v35, v19, v19 quad_perm:[2,3,0,1] row_mask:0xf bank_mask:0xf
  v_max3_f32 v72, v72, v32, v33
  v_max3_f32 v72, v72, v34, v35
  v_dot2_f32_bf16 v16, v144, v4, 0
  v_dot2_f32_bf16 v16, v145, v5, v16
  v_dot2_f32_bf16 v16, v146, v6, v16
  v_dot2_f32_bf16 v16, v147, v7, v16
  v_dot2_f32_bf16 v17, v148, v4, 0
  v_dot2_f32_bf16 v17, v149, v5, v17
  v_dot2_f32_bf16 v17, v150, v6, v17
  v_dot2_f32_bf16 v17, v151, v7, v17
  v_dot2_f32_bf16 v18, v152, v4, 0
  v_dot2_f32_bf16 v18, v153, v5, v18
  v_dot2_f32_bf16 v18, v154, v6, v18
  v_dot2_f32_bf16 v18, v155, v7, v18
  v_dot2_f32_bf16 v19, v156, v4, 0
  v_dot2_f32_bf16 v19, v157, v5, v19
  v_dot2_f32_bf16 v19, v158, v6, v19
  v_dot2_f32_bf16 v19, v159, v7, v19
  v_dot2_f32_bf16 v20, v160, v4, 0
  v_dot2_f32_bf16 v20, v161, v5, v20
  v_dot2_f32_bf16 v20, v162, v6, v20
  v_dot2_f32_bf16 v20, v163, v7, v20
  v_dot2_f32_bf16 v21, v164, v4, 0
  v_dot2_f32_bf16 v21, v165, v5, v21
  v_dot2_f32_bf16 v21, v166, v6, v21
  v_dot2_f32_bf16 v21, v167, v7, v21
  v_dot2_f32_bf16 v22, v168, v4, 0
  v_dot2_f32_bf16 v22, v169, v5, v22
  v_dot2_f32_bf16 v22, v170, v6, v22
  v_dot2_f32_bf16 v22, v171, v7, v22
  v_dot2_f32_bf16 v23, v172, v4, 0
  v_dot2_f32_bf16 v23, v173, v5, v23
  v_dot2_f32_bf16 v23, v174, v6, v23
  v_dot2_f32_bf16 v23, v175, v7, v23
  v_dot2_f32_bf16 v24, v176, v4, 0
  v_dot2_f32_bf16 v24, v177, v5, v24
  v_dot2_f32_bf16 v24, v178, v6, v24
  v_dot2_f32_bf16 v24, v179, v7, v24
  v_dot2_f32_bf16 v25, v180, v4, 0
  v_dot2_f32_bf16 v25, v181, v5, v25
  v_dot2_f32_bf16 v25, v182, v6, v25
  v_dot2_f32_bf16 v25, v183, v7, v25
  v_dot2_f32_bf16 v26, v184, v4, 0
  v_dot2_f32_bf16 v26, v185, v5, v26
  v_dot2_f32_bf16 v26, v186, v6, v26
  v_dot2_f32_bf16 v26, v187, v7, v26
  v_dot2_f32_bf16 v27, v188, v4, 0
  v_dot2_f32_bf16 v27, v189, v5, v27
  v_dot2_f32_bf16 v27, v190, v6, v27
  v_dot2_f32_bf16 v27, v191, v7, v27
  v_dot2_f32_bf16 v28, v192, v4, 0
  v_dot2_f32_bf16 v28, v193, v5, v28
  v_dot2_f32_bf16 v28, v194, v6, v28
  v_dot2_f32_bf16 v28, v195, v7, v28
  v_dot2_f32_bf16 v29, v196, v4, 0
  v_dot2_f32_bf16 v29, v197, v5, v29
  v_dot2_f32_bf16 v29, v198, v6, v29
  v_dot2_f32_bf16 v29, v199, v7, v29
  v_dot2_f32_bf16 v30, v200, v4, 0
  v_dot2_f32_bf16 v30, v201, v5, v30
  v_dot2_f32_bf16 v30, v202, v6, v30
  v_dot2_f32_bf16 v30, v203, v7, v30
  v_dot2_f32_bf16 v31, v204, v4, 0
  v_dot2_f32_bf16 v31, v205, v5, v31
  v_dot2_f32_bf16 v31, v206, v6, v31
  v_dot2_f32_bf16 v31, v207, v7, v31
  v_add_f32_dpp v16, v16, v16 row_ror:8 row_mask:0xf bank_mask:0x3
  v_add_f32_dpp v17, v17, v17 row_ror:8 row_mask:0xf bank_mask:0x3
  v_add_f32_dpp v18, v18, v18 row_ror:8 row_mask:0xf bank_mask:0x3
  v_add_f32_dpp v19, v19, v19 row_ror:8 row_mask:0xf bank_mask:0x3
  v_add_f32_dpp v20, v20, v20 row_ror:8 row_mask:0xf bank_mask:0x3
  v_add_f32_dpp v21, v21, v21 row_ror:8 row_mask:0xf bank_mask:0x3
  v_add_f32_dpp v22, v22, v22 row_ror:8 row_mask:0xf bank_mask:0x3
  v_add_f32_dpp v23, v23, v23 row_ror:8 row_mask:0xf bank_mask:0x3
  v_add_f32_dpp v16, v24, v24 row_ror:8 row_mask:0xf bank_mask:0xc
  v_add_f32_dpp v17, v25, v25 row_ror:8 row_mask:0xf bank_mask:0xc
  v_add_f32_dpp v18, v26, v26 row_ror:8 row_mask:0xf bank_mask:0xc
  v_add_f32_dpp v19, v27, v27 row_ror:8 row_mask:0xf bank_mask:0xc
  v_add_f32_dpp v20, v28, v28 row_ror:8 row_mask:0xf bank_mask:0xc
  v_add_f32_dpp v21, v29, v29 row_ror:8 row_mask:0xf bank_mask:0xc
  v_add_f32_dpp v22, v30, v30 row_ror:8 row_mask:0xf bank_mask:0xc
  v_add_f32_dpp v23, v31, v31 row_ror:8 row_mask:0xf bank_mask:0xc
  v_add_f32_dpp v16, v16, v16 row_half_mirror row_mask:0xf bank_mask:0x5
  v_add_f32_dpp v17, v17, v17 row_half_mirror row_mask:0xf bank_mask:0x5
  v_add_f32_dpp v18, v18, v18 row_half_mirror row_mask:0xf bank_mask:0x5
  v_add_f32_dpp v19, v19, v19 row_half_mirror row_mask:0xf bank_mask:0x5
  v_add_f32_dpp v16, v20, v20 row_half_mirror row_mask:0xf bank_mask:0xa
  v_add_f32_dpp v17, v21, v21 row_half_mirror row_mask:0xf bank_mask:0xa
  v_add_f32_dpp v18, v22, v22 row_half_mirror row_mask:0xf bank_mask:0xa
  v_add_f32_dpp v19, v23, v23 row_half_mirror row_mask:0xf bank_mask:0xa
  v_add_f32_dpp v16, v16, v16 quad_perm:[1,0,3,2] row_mask:0xf bank_mask:0xf
  v_add_f32_dpp v17, v17, v17 quad_perm:[1,0,3,2] row_mask:0xf bank_mask:0xf
  v_add_f32_dpp v18, v18, v18 quad_perm:[1,0,3,2] row_mask:0xf bank_mask:0xf
  v_add_f32_dpp v19, v19, v19 quad_perm:[1,0,3,2] row_mask:0xf bank_mask:0xf
  v_add_f32_dpp v36, v16, v16 quad_perm:[2,3,0,1] row_mask:0xf bank_mask:0xf
  v_add_f32_dpp v37, v17, v17 quad_perm:[2,3,0,1] row_mask:0xf bank_mask:0xf
  v_add_f32_dpp v38, v18, v18 quad_perm:[2,3,0,1] row_mask:0xf bank_mask:0xf
  v_add_f32_dpp v39, v19, v19 quad_perm:[2,3,0,1] row_mask:0xf bank_mask:0xf
  v_max3_f32 v72, v72, v36, v37
  v_max3_f32 v72, v72, v38, v39
  v_dot2_f32_bf16 v16, v208, v4, 0
  v_dot2_f32_bf16 v16, v209, v5, v16
  v_dot2_f32_bf16 v16, v210, v6, v16
  v_dot2_f32_bf16 v16, v211, v7, v16
  v_dot2_f32_bf16 v17, v212, v4, 0
  v_dot2_f32_bf16 v17, v213, v5, v17
  v_dot2_f32_bf16 v17, v214, v6, v17
  v_dot2_f32_bf16 v17, v215, v7, v17
  v_dot2_f32_bf16 v18, v216, v4, 0
  v_dot2_f32_bf16 v18, v217, v5, v18
  v_dot2_f32_bf16 v18, v218, v6, v18
  v_dot2_f32_bf16 v18, v219, v7, v18
  v_dot2_f32_bf16 v19, v220, v4, 0
  v_dot2_f32_bf16 v19, v221, v5, v19
  v_dot2_f32_bf16 v19, v222, v6, v19
  v_dot2_f32_bf16 v19, v223, v7, v19
  v_dot2_f32_bf16 v20, v224, v4, 0
  v_dot2_f32_bf16 v20, v225, v5, v20
  v_dot2_f32_bf16 v20, v226, v6, v20
  v_dot2_f32_bf16 v20, v227, v7, v20
  v_dot2_f32_bf16 v21, v228, v4, 0
  v_dot2_f32_bf16 v21, v229, v5, v21
  v_dot2_f32_bf16 v21, v230, v6, v21
  v_dot2_f32_bf16 v21, v231, v7, v21
  v_dot2_f32_bf16 v22, v232, v4, 0
  v_dot2_f32_bf16 v22, v233, v5, v22
  v_dot2_f32_bf16 v22, v234, v6, v22
  v_dot2_f32_bf16 v22, v235, v7, v22
  s_waitcnt vmcnt(9)
  v_dot2_f32_bf16 v23, v236, v4, 0
  v_dot2_f32_bf16 v23, v237, v5, v23
  v_dot2_f32_bf16 v23, v238, v6, v23
  v_dot2_f32_bf16 v23, v239, v7, v23
  s_waitcnt vmcnt(8)
  v_dot2_f32_bf16 v24, v240, v4, 0
  v_dot2_f32_bf16 v24, v241, v5, v24
  v_dot2_f32_bf16 v24, v242, v6, v24
  v_dot2_f32_bf16 v24, v243, v7, v24
  s_waitcnt vmcnt(7)
  v_dot2_f32_bf16 v25, v244, v4, 0
  v_dot2_f32_bf16 v25, v245, v5, v25
  v_dot2_f32_bf16 v25, v246, v6, v25
  v_dot2_f32_bf16 v25, v247, v7, v25
  s_waitcnt vmcnt(6)
  v_dot2_f32_bf16 v26, v248, v4, 0
  v_dot2_f32_bf16 v26, v249, v5, v26
  v_dot2_f32_bf16 v26, v250, v6, v26
  v_dot2_f32_bf16 v26, v251, v7, v26
  s_waitcnt vmcnt(5)
  v_dot2_f32_bf16 v27, v252, v4, 0
  v_dot2_f32_bf16 v27, v253, v5, v27
  v_dot2_f32_bf16 v27, v254, v6, v27
  v_dot2_f32_bf16 v27, v255, v7, v27
  s_waitcnt vmcnt(4)
  buffer_load_dwordx4 v[100:103], v2, s[36:39], s48 offen offset:1024 nt
  v_dot2_f32_bf16 v28, v80, v4, 0
  v_dot2_f32_bf16 v28, v81, v5, v28
  v_dot2_f32_bf16 v28, v82, v6, v28
  v_dot2_f32_bf16 v28, v83, v7, v28
  s_waitcnt vmcnt(4)
  buffer_load_dwordx4 v[104:107], v2, s[36:39], s48 offen offset:2048 nt
  v_dot2_f32_bf16 v29, v84, v4, 0
  v_dot2_f32_bf16 v29, v85, v5, v29
  v_dot2_f32_bf16 v29, v86, v6, v29
  v_dot2_f32_bf16 v29, v87, v7, v29
  s_waitcnt vmcnt(4)
  buffer_load_dwordx4 v[108:111], v2, s[36:39], s48 offen offset:3072 nt
  v_dot2_f32_bf16 v30, v88, v4, 0
  v_dot2_f32_bf16 v30, v89, v5, v30
  v_dot2_f32_bf16 v30, v90, v6, v30
  v_dot2_f32_bf16 v30, v91, v7, v30
  s_waitcnt vmcnt(4)
  s_mov_b32 s48, 212992
  buffer_load_dwordx4 v[112:115], v2, s[36:39], s48 offen offset:0 nt
  v_dot2_f32_bf16 v31, v92, v4, 0
  v_dot2_f32_bf16 v31, v93, v5, v31
  v_dot2_f32_bf16 v31, v94, v6, v31
  v_dot2_f32_bf16 v31, v95, v7, v31
  v_add_f32_dpp v16, v16, v16 row_ror:8 row_mask:0xf bank_mask:0x3
  v_add_f32_dpp v17, v17, v17 row_ror:8 row_mask:0xf bank_mask:0x3
  v_add_f32_dpp v18, v18, v18 row_ror:8 row_mask:0xf bank_mask:0x3
  v_add_f32_dpp v19, v19, v19 row_ror:8 row_mask:0xf bank_mask:0x3
  v_add_f32_dpp v20, v20, v20 row_ror:8 row_mask:0xf bank_mask:0x3
  v_add_f32_dpp v21, v21, v21 row_ror:8 row_mask:0xf bank_mask:0x3
  v_add_f32_dpp v22, v22, v22 row_ror:8 row_mask:0xf bank_mask:0x3
  v_add_f32_dpp v23, v23, v23 row_ror:8 row_mask:0xf bank_mask:0x3
  v_add_f32_dpp v16, v24, v24 row_ror:8 row_mask:0xf bank_mask:0xc
  v_add_f32_dpp v17, v25, v25 row_ror:8 row_mask:0xf bank_mask:0xc
  v_add_f32_dpp v18, v26, v26 row_ror:8 row_mask:0xf bank_mask:0xc
  v_add_f32_dpp v19, v27, v27 row_ror:8 row_mask:0xf bank_mask:0xc
  v_add_f32_dpp v20, v28, v28 row_ror:8 row_mask:0xf bank_mask:0xc
  v_add_f32_dpp v21, v29, v29 row_ror:8 row_mask:0xf bank_mask:0xc
  v_add_f32_dpp v22, v30, v30 row_ror:8 row_mask:0xf bank_mask:0xc
  v_add_f32_dpp v23, v31, v31 row_ror:8 row_mask:0xf bank_mask:0xc
  v_add_f32_dpp v16, v16, v16 row_half_mirror row_mask:0xf bank_mask:0x5
  v_add_f32_dpp v17, v17, v17 row_half_mirror row_mask:0xf bank_mask:0x5
  v_add_f32_dpp v18, v18, v18 row_half_mirror row_mask:0xf bank_mask:0x5
  v_add_f32_dpp v19, v19, v19 row_half_mirror row_mask:0xf bank_mask:0x5
  v_add_f32_dpp v16, v20, v20 row_half_mirror row_mask:0xf bank_mask:0xa
  v_add_f32_dpp v17, v21, v21 row_half_mirror row_mask:0xf bank_mask:0xa
  v_add_f32_dpp v18, v22, v22 row_half_mirror row_mask:0xf bank_mask:0xa
  v_add_f32_dpp v19, v23, v23 row_half_mirror row_mask:0xf bank_mask:0xa
  v_add_f32_dpp v16, v16, v16 quad_perm:[1,0,3,2] row_mask:0xf bank_mask:0xf
  v_add_f32_dpp v17, v17, v17 quad_perm:[1,0,3,2] row_mask:0xf bank_mask:0xf
  v_add_f32_dpp v18, v18, v18 quad_perm:[1,0,3,2] row_mask:0xf bank_mask:0xf
  v_add_f32_dpp v19, v19, v19 quad_perm:[1,0,3,2] row_mask:0xf bank_mask:0xf
  v_add_f32_dpp v40, v16, v16 quad_perm:[2,3,0,1] row_mask:0xf bank_mask:0xf
  v_add_f32_dpp v41, v17, v17 quad_perm:[2,3,0,1] row_mask:0xf bank_mask:0xf
  v_add_f32_dpp v42, v18, v18 quad_perm:[2,3,0,1] row_mask:0xf bank_mask:0xf
  v_add_f32_dpp v43, v19, v19 quad_perm:[2,3,0,1] row_mask:0xf bank_mask:0xf
  v_max3_f32 v72, v72, v40, v41
  v_max3_f32 v72, v72, v42, v43
  s_waitcnt vmcnt(4)
  buffer_load_dwordx4 v[116:119], v2, s[36:39], s48 offen offset:1024 nt
  v_dot2_f32_bf16 v16, v96, v4, 0
  v_dot2_f32_bf16 v16, v97, v5, v16
  v_dot2_f32_bf16 v16, v98, v6, v16
  v_dot2_f32_bf16 v16, v99, v7, v16
  s_waitcnt vmcnt(4)
  buffer_load_dwordx4 v[120:123], v2, s[36:39], s48 offen offset:2048 nt
  v_dot2_f32_bf16 v17, v100, v4, 0
  v_dot2_f32_bf16 v17, v101, v5, v17
  v_dot2_f32_bf16 v17, v102, v6, v17
  v_dot2_f32_bf16 v17, v103, v7, v17
  s_waitcnt vmcnt(4)
  buffer_load_dwordx4 v[124:127], v2, s[36:39], s48 offen offset:3072 nt
  v_dot2_f32_bf16 v18, v104, v4, 0
  v_dot2_f32_bf16 v18, v105, v5, v18
  v_dot2_f32_bf16 v18, v106, v6, v18
  v_dot2_f32_bf16 v18, v107, v7, v18
  s_waitcnt vmcnt(4)
  s_mov_b32 s48, 229376
  buffer_load_dwordx4 v[128:131], v2, s[36:39], s48 offen offset:0 nt
  v_dot2_f32_bf16 v19, v108, v4, 0
  v_dot2_f32_bf16 v19, v109, v5, v19
  v_dot2_f32_bf16 v19, v110, v6, v19
  v_dot2_f32_bf16 v19, v111, v7, v19
  s_waitcnt vmcnt(4)
  buffer_load_dwordx4 v[132:135], v2, s[36:39], s48 offen offset:1024 nt
  v_dot2_f32_bf16 v20, v112, v4, 0
  v_dot2_f32_bf16 v20, v113, v5, v20
  v_dot2_f32_bf16 v20, v114, v6, v20
  v_dot2_f32_bf16 v20, v115, v7, v20
  s_waitcnt vmcnt(4)
  buffer_load_dwordx4 v[136:139], v2, s[36:39], s48 offen offset:2048 nt
  v_dot2_f32_bf16 v21, v116, v4, 0
  v_dot2_f32_bf16 v21, v117, v5, v21
  v_dot2_f32_bf16 v21, v118, v6, v21
  v_dot2_f32_bf16 v21, v119, v7, v21
  s_waitcnt vmcnt(4)
  buffer_load_dwordx4 v[140:143], v2, s[36:39], s48 offen offset:3072 nt
  v_dot2_f32_bf16 v22, v120, v4, 0
  v_dot2_f32_bf16 v22, v121, v5, v22
  v_dot2_f32_bf16 v22, v122, v6, v22
  v_dot2_f32_bf16 v22, v123, v7, v22
  s_waitcnt vmcnt(4)
  s_mov_b32 s48, 245760
  buffer_load_dwordx4 v[144:147], v2, s[36:39], s48 offen offset:0 nt
  v_dot2_f32_bf16 v23, v124, v4, 0
  v_dot2_f32_bf16 v23, v125, v5, v23
  v_dot2_f32_bf16 v23, v126, v6, v23
  v_dot2_f32_bf16 v23, v127, v7, v23
  s_waitcnt vmcnt(4)
  buffer_load_dwordx4 v[148:151], v2, s[36:39], s48 offen offset:1024 nt
  v_dot2_f32_bf16 v24, v128, v4, 0
  v_dot2_f32_bf16 v24, v129, v5, v24
  v_dot2_f32_bf16 v24, v130, v6, v24
  v_dot2_f32_bf16 v24, v131, v7, v24
  s_waitcnt vmcnt(4)
  buffer_load_dwordx4 v[152:155], v2, s[36:39], s48 offen offset:2048 nt
  v_dot2_f32_bf16 v25, v132, v4, 0
  v_dot2_f32_bf16 v25, v133, v5, v25
  v_dot2_f32_bf16 v25, v134, v6, v25
  v_dot2_f32_bf16 v25, v135, v7, v25
  s_waitcnt vmcnt(4)
  buffer_load_dwordx4 v[156:159], v2, s[36:39], s48 offen offset:3072 nt
  v_dot2_f32_bf16 v26, v136, v4, 0
  v_dot2_f32_bf16 v26, v137, v5, v26
  v_dot2_f32_bf16 v26, v138, v6, v26
  v_dot2_f32_bf16 v26, v139, v7, v26
  s_waitcnt vmcnt(4)
  s_mov_b32 s48, 262144
  buffer_load_dwordx4 v[160:163], v2, s[36:39], s48 offen offset:0 nt
  v_dot2_f32_bf16 v27, v140, v4, 0
  v_dot2_f32_bf16 v27, v141, v5, v27
  v_dot2_f32_bf16 v27, v142, v6, v27
  v_dot2_f32_bf16 v27, v143, v7, v27
  s_waitcnt vmcnt(4)
  buffer_load_dwordx4 v[164:167], v2, s[36:39], s48 offen offset:1024 nt
  v_dot2_f32_bf16 v28, v144, v4, 0
  v_dot2_f32_bf16 v28, v145, v5, v28
  v_dot2_f32_bf16 v28, v146, v6, v28
  v_dot2_f32_bf16 v28, v147, v7, v28
  s_waitcnt vmcnt(4)
  buffer_load_dwordx4 v[168:171], v2, s[36:39], s48 offen offset:2048 nt
  v_dot2_f32_bf16 v29, v148, v4, 0
  v_dot2_f32_bf16 v29, v149, v5, v29
  v_dot2_f32_bf16 v29, v150, v6, v29
  v_dot2_f32_bf16 v29, v151, v7, v29
  s_waitcnt vmcnt(4)
  buffer_load_dwordx4 v[172:175], v2, s[36:39], s48 offen offset:3072 nt
  v_dot2_f32_bf16 v30, v152, v4, 0
  v_dot2_f32_bf16 v30, v153, v5, v30
  v_dot2_f32_bf16 v30, v154, v6, v30
  v_dot2_f32_bf16 v30, v155, v7, v30
  s_waitcnt vmcnt(4)
  s_mov_b32 s48, 278528
  buffer_load_dwordx4 v[176:179], v2, s[36:39], s48 offen offset:0 nt
  v_dot2_f32_bf16 v31, v156, v4, 0
  v_dot2_f32_bf16 v31, v157, v5, v31
  v_dot2_f32_bf16 v31, v158, v6, v31
  v_dot2_f32_bf16 v31, v159, v7, v31
  v_add_f32_dpp v16, v16, v16 row_ror:8 row_mask:0xf bank_mask:0x3
  v_add_f32_dpp v17, v17, v17 row_ror:8 row_mask:0xf bank_mask:0x3
  v_add_f32_dpp v18, v18, v18 row_ror:8 row_mask:0xf bank_mask:0x3
  v_add_f32_dpp v19, v19, v19 row_ror:8 row_mask:0xf bank_mask:0x3
  v_add_f32_dpp v20, v20, v20 row_ror:8 row_mask:0xf bank_mask:0x3
  v_add_f32_dpp v21, v21, v21 row_ror:8 row_mask:0xf bank_mask:0x3
  v_add_f32_dpp v22, v22, v22 row_ror:8 row_mask:0xf bank_mask:0x3
  v_add_f32_dpp v23, v23, v23 row_ror:8 row_mask:0xf bank_mask:0x3
  v_add_f32_dpp v16, v24, v24 row_ror:8 row_mask:0xf bank_mask:0xc
  v_add_f32_dpp v17, v25, v25 row_ror:8 row_mask:0xf bank_mask:0xc
  v_add_f32_dpp v18, v26, v26 row_ror:8 row_mask:0xf bank_mask:0xc
  v_add_f32_dpp v19, v27, v27 row_ror:8 row_mask:0xf bank_mask:0xc
  v_add_f32_dpp v20, v28, v28 row_ror:8 row_mask:0xf bank_mask:0xc
  v_add_f32_dpp v21, v29, v29 row_ror:8 row_mask:0xf bank_mask:0xc
  v_add_f32_dpp v22, v30, v30 row_ror:8 row_mask:0xf bank_mask:0xc
  v_add_f32_dpp v23, v31, v31 row_ror:8 row_mask:0xf bank_mask:0xc
  v_add_f32_dpp v16, v16, v16 row_half_mirror row_mask:0xf bank_mask:0x5
  v_add_f32_dpp v17, v17, v17 row_half_mirror row_mask:0xf bank_mask:0x5
  v_add_f32_dpp v18, v18, v18 row_half_mirror row_mask:0xf bank_mask:0x5
  v_add_f32_dpp v19, v19, v19 row_half_mirror row_mask:0xf bank_mask:0x5
  v_add_f32_dpp v16, v20, v20 row_half_mirror row_mask:0xf bank_mask:0xa
  v_add_f32_dpp v17, v21, v21 row_half_mirror row_mask:0xf bank_mask:0xa
  v_add_f32_dpp v18, v22, v22 row_half_mirror row_mask:0xf bank_mask:0xa
  v_add_f32_dpp v19, v23, v23 row_half_mirror row_mask:0xf bank_mask:0xa
  v_add_f32_dpp v16, v16, v16 quad_perm:[1,0,3,2] row_mask:0xf bank_mask:0xf
  v_add_f32_dpp v17, v17, v17 quad_perm:[1,0,3,2] row_mask:0xf bank_mask:0xf
  v_add_f32_dpp v18, v18, v18 quad_perm:[1,0,3,2] row_mask:0xf bank_mask:0xf
  v_add_f32_dpp v19, v19, v19 quad_perm:[1,0,3,2] row_mask:0xf bank_mask:0xf
  v_add_f32_dpp v44, v16, v16 quad_perm:[2,3,0,1] row_mask:0xf bank_mask:0xf
  v_add_f32_dpp v45, v17, v17 quad_perm:[2,3,0,1] row_mask:0xf bank_mask:0xf
  v_add_f32_dpp v46, v18, v18 quad_perm:[2,3,0,1] row_mask:0xf bank_mask:0xf
  v_add_f32_dpp v47, v19, v19 quad_perm:[2,3,0,1] row_mask:0xf bank_mask:0xf
  v_max3_f32 v72, v72, v44, v45
  v_max3_f32 v72, v72, v46, v47
  s_waitcnt vmcnt(4)
  buffer_load_dwordx4 v[180:183], v2, s[36:39], s48 offen offset:1024 nt
  v_dot2_f32_bf16 v16, v160, v4, 0
  v_dot2_f32_bf16 v16, v161, v5, v16
  v_dot2_f32_bf16 v16, v162, v6, v16
  v_dot2_f32_bf16 v16, v163, v7, v16
  s_waitcnt vmcnt(4)
  buffer_load_dwordx4 v[184:187], v2, s[36:39], s48 offen offset:2048 nt
  v_dot2_f32_bf16 v17, v164, v4, 0
  v_dot2_f32_bf16 v17, v165, v5, v17
  v_dot2_f32_bf16 v17, v166, v6, v17
  v_dot2_f32_bf16 v17, v167, v7, v17
  s_waitcnt vmcnt(4)
  buffer_load_dwordx4 v[188:191], v2, s[36:39], s48 offen offset:3072 nt
  v_dot2_f32_bf16 v18, v168, v4, 0
  v_dot2_f32_bf16 v18, v169, v5, v18
  v_dot2_f32_bf16 v18, v170, v6, v18
  v_dot2_f32_bf16 v18, v171, v7, v18
  s_waitcnt vmcnt(4)
  s_mov_b32 s48, 294912
  buffer_load_dwordx4 v[192:195], v2, s[36:39], s48 offen offset:0 nt
  v_dot2_f32_bf16 v19, v172, v4, 0
  v_dot2_f32_bf16 v19, v173, v5, v19
  v_dot2_f32_bf16 v19, v174, v6, v19
  v_dot2_f32_bf16 v19, v175, v7, v19
  s_waitcnt vmcnt(4)
  buffer_load_dwordx4 v[196:199], v2, s[36:39], s48 offen offset:1024 nt
  v_dot2_f32_bf16 v20, v176, v4, 0
  v_dot2_f32_bf16 v20, v177, v5, v20
  v_dot2_f32_bf16 v20, v178, v6, v20
  v_dot2_f32_bf16 v20, v179, v7, v20
  s_waitcnt vmcnt(4)
  buffer_load_dwordx4 v[200:203], v2, s[36:39], s48 offen offset:2048 nt
  v_dot2_f32_bf16 v21, v180, v4, 0
  v_dot2_f32_bf16 v21, v181, v5, v21
  v_dot2_f32_bf16 v21, v182, v6, v21
  v_dot2_f32_bf16 v21, v183, v7, v21
  s_waitcnt vmcnt(4)
  buffer_load_dwordx4 v[204:207], v2, s[36:39], s48 offen offset:3072 nt
  v_dot2_f32_bf16 v22, v184, v4, 0
  v_dot2_f32_bf16 v22, v185, v5, v22
  v_dot2_f32_bf16 v22, v186, v6, v22
  v_dot2_f32_bf16 v22, v187, v7, v22
  s_waitcnt vmcnt(4)
  s_mov_b32 s48, 311296
  buffer_load_dwordx4 v[208:211], v2, s[36:39], s48 offen offset:0 nt
  v_dot2_f32_bf16 v23, v188, v4, 0
  v_dot2_f32_bf16 v23, v189, v5, v23
  v_dot2_f32_bf16 v23, v190, v6, v23
  v_dot2_f32_bf16 v23, v191, v7, v23
  s_waitcnt vmcnt(4)
  buffer_load_dwordx4 v[212:215], v2, s[36:39], s48 offen offset:1024 nt
  v_dot2_f32_bf16 v24, v192, v4, 0
  v_dot2_f32_bf16 v24, v193, v5, v24
  v_dot2_f32_bf16 v24, v194, v6, v24
  v_dot2_f32_bf16 v24, v195, v7, v24
  s_waitcnt vmcnt(4)
  buffer_load_dwordx4 v[216:219], v2, s[36:39], s48 offen offset:2048 nt
  v_dot2_f32_bf16 v25, v196, v4, 0
  v_dot2_f32_bf16 v25, v197, v5, v25
  v_dot2_f32_bf16 v25, v198, v6, v25
  v_dot2_f32_bf16 v25, v199, v7, v25
  s_waitcnt vmcnt(4)
  buffer_load_dwordx4 v[220:223], v2, s[36:39], s48 offen offset:3072 nt
  v_dot2_f32_bf16 v26, v200, v4, 0
  v_dot2_f32_bf16 v26, v201, v5, v26
  v_dot2_f32_bf16 v26, v202, v6, v26
  v_dot2_f32_bf16 v26, v203, v7, v26
  s_waitcnt vmcnt(4)
  s_mov_b32 s48, 327680
  buffer_load_dwordx4 v[224:227], v2, s[36:39], s48 offen offset:0 nt
  v_dot2_f32_bf16 v27, v204, v4, 0
  v_dot2_f32_bf16 v27, v205, v5, v27
  v_dot2_f32_bf16 v27, v206, v6, v27
  v_dot2_f32_bf16 v27, v207, v7, v27
  s_waitcnt vmcnt(4)
  buffer_load_dwordx4 v[228:231], v2, s[36:39], s48 offen offset:1024 nt
  v_dot2_f32_bf16 v28, v208, v4, 0
  v_dot2_f32_bf16 v28, v209, v5, v28
  v_dot2_f32_bf16 v28, v210, v6, v28
  v_dot2_f32_bf16 v28, v211, v7, v28
  s_waitcnt vmcnt(4)
  buffer_load_dwordx4 v[232:235], v2, s[36:39], s48 offen offset:2048 nt
  v_dot2_f32_bf16 v29, v212, v4, 0
  v_dot2_f32_bf16 v29, v213, v5, v29
  v_dot2_f32_bf16 v29, v214, v6, v29
  v_dot2_f32_bf16 v29, v215, v7, v29
  s_waitcnt vmcnt(4)
  buffer_load_dwordx4 v[236:239], v2, s[36:39], s48 offen offset:3072 nt
  v_dot2_f32_bf16 v30, v216, v4, 0
  v_dot2_f32_bf16 v30, v217, v5, v30
  v_dot2_f32_bf16 v30, v218, v6, v30
  v_dot2_f32_bf16 v30, v219, v7, v30
  s_waitcnt vmcnt(4)
  s_mov_b32 s48, 344064
  buffer_load_dwordx4 v[240:243], v2, s[36:39], s48 offen offset:0 nt
  v_dot2_f32_bf16 v31, v220, v4, 0
  v_dot2_f32_bf16 v31, v221, v5, v31
  v_dot2_f32_bf16 v31, v222, v6, v31
  v_dot2_f32_bf16 v31, v223, v7, v31
  v_add_f32_dpp v16, v16, v16 row_ror:8 row_mask:0xf bank_mask:0x3
  v_add_f32_dpp v17, v17, v17 row_ror:8 row_mask:0xf bank_mask:0x3
  v_add_f32_dpp v18, v18, v18 row_ror:8 row_mask:0xf bank_mask:0x3
  v_add_f32_dpp v19, v19, v19 row_ror:8 row_mask:0xf bank_mask:0x3
  v_add_f32_dpp v20, v20, v20 row_ror:8 row_mask:0xf bank_mask:0x3
  v_add_f32_dpp v21, v21, v21 row_ror:8 row_mask:0xf bank_mask:0x3
  v_add_f32_dpp v22, v22, v22 row_ror:8 row_mask:0xf bank_mask:0x3
  v_add_f32_dpp v23, v23, v23 row_ror:8 row_mask:0xf bank_mask:0x3
  v_add_f32_dpp v16, v24, v24 row_ror:8 row_mask:0xf bank_mask:0xc
  v_add_f32_dpp v17, v25, v25 row_ror:8 row_mask:0xf bank_mask:0xc
  v_add_f32_dpp v18, v26, v26 row_ror:8 row_mask:0xf bank_mask:0xc
  v_add_f32_dpp v19, v27, v27 row_ror:8 row_mask:0xf bank_mask:0xc
  v_add_f32_dpp v20, v28, v28 row_ror:8 row_mask:0xf bank_mask:0xc
  v_add_f32_dpp v21, v29, v29 row_ror:8 row_mask:0xf bank_mask:0xc
  v_add_f32_dpp v22, v30, v30 row_ror:8 row_mask:0xf bank_mask:0xc
  v_add_f32_dpp v23, v31, v31 row_ror:8 row_mask:0xf bank_mask:0xc
  v_add_f32_dpp v16, v16, v16 row_half_mirror row_mask:0xf bank_mask:0x5
  v_add_f32_dpp v17, v17, v17 row_half_mirror row_mask:0xf bank_mask:0x5
  v_add_f32_dpp v18, v18, v18 row_half_mirror row_mask:0xf bank_mask:0x5
  v_add_f32_dpp v19, v19, v19 row_half_mirror row_mask:0xf bank_mask:0x5
  v_add_f32_dpp v16, v20, v20 row_half_mirror row_mask:0xf bank_mask:0xa
  v_add_f32_dpp v17, v21, v21 row_half_mirror row_mask:0xf bank_mask:0xa
  v_add_f32_dpp v18, v22, v22 row_half_mirror row_mask:0xf bank_mask:0xa
  v_add_f32_dpp v19, v23, v23 row_half_mirror row_mask:0xf bank_mask:0xa
  v_add_f32_dpp v16, v16, v16 quad_perm:[1,0,3,2] row_mask:0xf bank_mask:0xf
  v_add_f32_dpp v17, v17, v17 quad_perm:[1,0,3,2] row_mask:0xf bank_mask:0xf
  v_add_f32_dpp v18, v18, v18 quad_perm:[1,0,3,2] row_mask:0xf bank_mask:0xf
  v_add_f32_dpp v19, v19, v19 quad_perm:[1,0,3,2] row_mask:0xf bank_mask:0xf
  v_add_f32_dpp v48, v16, v16 quad_perm:[2,3,0,1] row_mask:0xf bank_mask:0xf
  v_add_f32_dpp v49, v17, v17 quad_perm:[2,3,0,1] row_mask:0xf bank_mask:0xf
  v_add_f32_dpp v50, v18, v18 quad_perm:[2,3,0,1] row_mask:0xf bank_mask:0xf
  v_add_f32_dpp v51, v19, v19 quad_perm:[2,3,0,1] row_mask:0xf bank_mask:0xf
  v_max3_f32 v72, v72, v48, v49
  v_max3_f32 v72, v72, v50, v51
  s_waitcnt vmcnt(4)
  buffer_load_dwordx4 v[244:247], v2, s[36:39], s48 offen offset:1024 nt
  v_dot2_f32_bf16 v16, v224, v4, 0
  v_dot2_f32_bf16 v16, v225, v5, v16
  v_dot2_f32_bf16 v16, v226, v6, v16
  v_dot2_f32_bf16 v16, v227, v7, v16
  s_waitcnt vmcnt(4)
  buffer_load_dwordx4 v[248:251], v2, s[36:39], s48 offen offset:2048 nt
  v_dot2_f32_bf16 v17, v228, v4, 0
  v_dot2_f32_bf16 v17, v229, v5, v17
  v_dot2_f32_bf16 v17, v230, v6, v17
  v_dot2_f32_bf16 v17, v231, v7, v17
  s_waitcnt vmcnt(4)
  buffer_load_dwordx4 v[252:255], v2, s[36:39], s48 offen offset:3072 nt
  v_dot2_f32_bf16 v18, v232, v4, 0
  v_dot2_f32_bf16 v18, v233, v5, v18
  v_dot2_f32_bf16 v18, v234, v6, v18
  v_dot2_f32_bf16 v18, v235, v7, v18
  s_waitcnt vmcnt(4)
  s_mov_b32 s48, 360448
  buffer_load_dwordx4 v[80:83], v2, s[36:39], s48 offen offset:0 nt
  v_dot2_f32_bf16 v19, v236, v4, 0
  v_dot2_f32_bf16 v19, v237, v5, v19
  v_dot2_f32_bf16 v19, v238, v6, v19
  v_dot2_f32_bf16 v19, v239, v7, v19
  s_waitcnt vmcnt(4)
  buffer_load_dwordx4 v[84:87], v2, s[36:39], s48 offen offset:1024 nt
  v_dot2_f32_bf16 v20, v240, v4, 0
  v_dot2_f32_bf16 v20, v241, v5, v20
  v_dot2_f32_bf16 v20, v242, v6, v20
  v_dot2_f32_bf16 v20, v243, v7, v20
  s_waitcnt vmcnt(4)
  buffer_load_dwordx4 v[88:91], v2, s[36:39], s48 offen offset:2048 nt
  v_dot2_f32_bf16 v21, v244, v4, 0
  v_dot2_f32_bf16 v21, v245, v5, v21
  v_dot2_f32_bf16 v21, v246, v6, v21
  v_dot2_f32_bf16 v21, v247, v7, v21
  s_waitcnt vmcnt(4)
  buffer_load_dwordx4 v[92:95], v2, s[36:39], s48 offen offset:3072 nt
  v_dot2_f32_bf16 v22, v248, v4, 0
  v_dot2_f32_bf16 v22, v249, v5, v22
  v_dot2_f32_bf16 v22, v250, v6, v22
  v_dot2_f32_bf16 v22, v251, v7, v22
  s_waitcnt vmcnt(4)
  s_mov_b32 s48, 376832
  buffer_load_dwordx4 v[96:99], v2, s[36:39], s48 offen offset:0 nt
  v_dot2_f32_bf16 v23, v252, v4, 0
  v_dot2_f32_bf16 v23, v253, v5, v23
  v_dot2_f32_bf16 v23, v254, v6, v23
  v_dot2_f32_bf16 v23, v255, v7, v23
  s_waitcnt vmcnt(4)
  buffer_load_dwordx4 v[100:103], v2, s[36:39], s48 offen offset:1024 nt
  v_dot2_f32_bf16 v24, v80, v4, 0
  v_dot2_f32_bf16 v24, v81, v5, v24
  v_dot2_f32_bf16 v24, v82, v6, v24
  v_dot2_f32_bf16 v24, v83, v7, v24
  v_mov_b32 v76, 14224
  v_mov_b32 v77, 1
  s_mov_b64 exec, 1
  ds_max_u32 v76, v77
  s_mov_b64 exec, -1
  s_waitcnt vmcnt(4)
  buffer_load_dwordx4 v[104:107], v2, s[36:39], s48 offen offset:2048 nt
  v_dot2_f32_bf16 v25, v84, v4, 0
  v_dot2_f32_bf16 v25, v85, v5, v25
  v_dot2_f32_bf16 v25, v86, v6, v25
  v_dot2_f32_bf16 v25, v87, v7, v25
  s_waitcnt vmcnt(4)
  buffer_load_dwordx4 v[108:111], v2, s[36:39], s48 offen offset:3072 nt
  v_dot2_f32_bf16 v26, v88, v4, 0
  v_dot2_f32_bf16 v26, v89, v5, v26
  v_dot2_f32_bf16 v26, v90, v6, v26
  v_dot2_f32_bf16 v26, v91, v7, v26
  s_waitcnt vmcnt(4)
  s_mov_b32 s48, 393216
  buffer_load_dwordx4 v[112:115], v2, s[36:39], s48 offen offset:0 nt
  v_dot2_f32_bf16 v27, v92, v4, 0
  v_dot2_f32_bf16 v27, v93, v5, v27
  v_dot2_f32_bf16 v27, v94, v6, v27
  v_dot2_f32_bf16 v27, v95, v7, v27
  s_waitcnt vmcnt(4)
  buffer_load_dwordx4 v[116:119], v2, s[36:39], s48 offen offset:1024 nt
  v_dot2_f32_bf16 v28, v96, v4, 0
  v_dot2_f32_bf16 v28, v97, v5, v28
  v_dot2_f32_bf16 v28, v98, v6, v28
  v_dot2_f32_bf16 v28, v99, v7, v28
  s_waitcnt vmcnt(4)
  buffer_load_dwordx4 v[120:123], v2, s[36:39], s48 offen offset:2048 nt
  v_dot2_f32_bf16 v29, v100, v4, 0
  v_dot2_f32_bf16 v29, v101, v5, v29
  v_dot2_f32_bf16 v29, v102, v6, v29
  v_dot2_f32_bf16 v29, v103, v7, v29
  s_waitcnt vmcnt(4)
  buffer_load_dwordx4 v[124:127], v2, s[36:39], s48 offen offset:3072 nt
  v_dot2_f32_bf16 v30, v104, v4, 0
  v_dot2_f32_bf16 v30, v105, v5, v30
  v_dot2_f32_bf16 v30, v106, v6, v30
  v_dot2_f32_bf16 v30, v107, v7, v30
  s_waitcnt vmcnt(4)
  s_mov_b32 s48, 409600
  buffer_load_dwordx4 v[128:131], v2, s[36:39], s48 offen offset:0 nt
  v_dot2_f32_bf16 v31, v108, v4, 0
  v_dot2_f32_bf16 v31, v109, v5, v31
  v_dot2_f32_bf16 v31, v110, v6, v31
  v_dot2_f32_bf16 v31, v111, v7, v31
  v_add_f32_dpp v16, v16, v16 row_ror:8 row_mask:0xf bank_mask:0x3
  v_add_f32_dpp v17, v17, v17 row_ror:8 row_mask:0xf bank_mask:0x3
  v_add_f32_dpp v18, v18, v18 row_ror:8 row_mask:0xf bank_mask:0x3
  v_add_f32_dpp v19, v19, v19 row_ror:8 row_mask:0xf bank_mask:0x3
  v_add_f32_dpp v20, v20, v20 row_ror:8 row_mask:0xf bank_mask:0x3
  v_add_f32_dpp v21, v21, v21 row_ror:8 row_mask:0xf bank_mask:0x3
  v_add_f32_dpp v22, v22, v22 row_ror:8 row_mask:0xf bank_mask:0x3
  v_add_f32_dpp v23, v23, v23 row_ror:8 row_mask:0xf bank_mask:0x3
  v_add_f32_dpp v16, v24, v24 row_ror:8 row_mask:0xf bank_mask:0xc
  v_add_f32_dpp v17, v25, v25 row_ror:8 row_mask:0xf bank_mask:0xc
  v_add_f32_dpp v18, v26, v26 row_ror:8 row_mask:0xf bank_mask:0xc
  v_add_f32_dpp v19, v27, v27 row_ror:8 row_mask:0xf bank_mask:0xc
  v_add_f32_dpp v20, v28, v28 row_ror:8 row_mask:0xf bank_mask:0xc
  v_add_f32_dpp v21, v29, v29 row_ror:8 row_mask:0xf bank_mask:0xc
  v_add_f32_dpp v22, v30, v30 row_ror:8 row_mask:0xf bank_mask:0xc
  v_add_f32_dpp v23, v31, v31 row_ror:8 row_mask:0xf bank_mask:0xc
  v_add_f32_dpp v16, v16, v16 row_half_mirror row_mask:0xf bank_mask:0x5
  v_add_f32_dpp v17, v17, v17 row_half_mirror row_mask:0xf bank_mask:0x5
  v_add_f32_dpp v18, v18, v18 row_half_mirror row_mask:0xf bank_mask:0x5
  v_add_f32_dpp v19, v19, v19 row_half_mirror row_mask:0xf bank_mask:0x5
  v_add_f32_dpp v16, v20, v20 row_half_mirror row_mask:0xf bank_mask:0xa
  v_add_f32_dpp v17, v21, v21 row_half_mirror row_mask:0xf bank_mask:0xa
  v_add_f32_dpp v18, v22, v22 row_half_mirror row_mask:0xf bank_mask:0xa
  v_add_f32_dpp v19, v23, v23 row_half_mirror row_mask:0xf bank_mask:0xa
  v_add_f32_dpp v16, v16, v16 quad_perm:[1,0,3,2] row_mask:0xf bank_mask:0xf
  v_add_f32_dpp v17, v17, v17 quad_perm:[1,0,3,2] row_mask:0xf bank_mask:0xf
  v_add_f32_dpp v18, v18, v18 quad_perm:[1,0,3,2] row_mask:0xf bank_mask:0xf
  v_add_f32_dpp v19, v19, v19 quad_perm:[1,0,3,2] row_mask:0xf bank_mask:0xf
  v_add_f32_dpp v52, v16, v16 quad_perm:[2,3,0,1] row_mask:0xf bank_mask:0xf
  v_add_f32_dpp v53, v17, v17 quad_perm:[2,3,0,1] row_mask:0xf bank_mask:0xf
  v_add_f32_dpp v54, v18, v18 quad_perm:[2,3,0,1] row_mask:0xf bank_mask:0xf
  v_add_f32_dpp v55, v19, v19 quad_perm:[2,3,0,1] row_mask:0xf bank_mask:0xf
  v_max3_f32 v72, v72, v52, v53
  v_max3_f32 v72, v72, v54, v55
  s_waitcnt vmcnt(4)
  buffer_load_dwordx4 v[132:135], v2, s[36:39], s48 offen offset:1024 nt
  v_dot2_f32_bf16 v16, v112, v4, 0
  v_dot2_f32_bf16 v16, v113, v5, v16
  v_dot2_f32_bf16 v16, v114, v6, v16
  v_dot2_f32_bf16 v16, v115, v7, v16
  s_waitcnt vmcnt(4)
  buffer_load_dwordx4 v[136:139], v2, s[36:39], s48 offen offset:2048 nt
  v_dot2_f32_bf16 v17, v116, v4, 0
  v_dot2_f32_bf16 v17, v117, v5, v17
  v_dot2_f32_bf16 v17, v118, v6, v17
  v_dot2_f32_bf16 v17, v119, v7, v17
  s_waitcnt vmcnt(4)
  buffer_load_dwordx4 v[140:143], v2, s[36:39], s48 offen offset:3072 nt
  v_dot2_f32_bf16 v18, v120, v4, 0
  v_dot2_f32_bf16 v18, v121, v5, v18
  v_dot2_f32_bf16 v18, v122, v6, v18
  v_dot2_f32_bf16 v18, v123, v7, v18
  s_waitcnt vmcnt(4)
  s_mov_b32 s48, 425984
  buffer_load_dwordx4 v[144:147], v2, s[36:39], s48 offen offset:0 nt
  v_dot2_f32_bf16 v19, v124, v4, 0
  v_dot2_f32_bf16 v19, v125, v5, v19
  v_dot2_f32_bf16 v19, v126, v6, v19
  v_dot2_f32_bf16 v19, v127, v7, v19
  s_waitcnt vmcnt(4)
  buffer_load_dwordx4 v[148:151], v2, s[36:39], s48 offen offset:1024 nt
  v_dot2_f32_bf16 v20, v128, v4, 0
  v_dot2_f32_bf16 v20, v129, v5, v20
  v_dot2_f32_bf16 v20, v130, v6, v20
  v_dot2_f32_bf16 v20, v131, v7, v20
  s_waitcnt vmcnt(4)
  buffer_load_dwordx4 v[152:155], v2, s[36:39], s48 offen offset:2048 nt
  v_dot2_f32_bf16 v21, v132, v4, 0
  v_dot2_f32_bf16 v21, v133, v5, v21
  v_dot2_f32_bf16 v21, v134, v6, v21
  v_dot2_f32_bf16 v21, v135, v7, v21
  s_waitcnt vmcnt(4)
  buffer_load_dwordx4 v[156:159], v2, s[36:39], s48 offen offset:3072 nt
  v_dot2_f32_bf16 v22, v136, v4, 0
  v_dot2_f32_bf16 v22, v137, v5, v22
  v_dot2_f32_bf16 v22, v138, v6, v22
  v_dot2_f32_bf16 v22, v139, v7, v22
  s_waitcnt vmcnt(4)
  s_mov_b32 s48, 442368
  buffer_load_dwordx4 v[160:163], v2, s[36:39], s48 offen offset:0 nt
  v_dot2_f32_bf16 v23, v140, v4, 0
  v_dot2_f32_bf16 v23, v141, v5, v23
  v_dot2_f32_bf16 v23, v142, v6, v23
  v_dot2_f32_bf16 v23, v143, v7, v23
  s_waitcnt vmcnt(4)
  buffer_load_dwordx4 v[164:167], v2, s[36:39], s48 offen offset:1024 nt
  v_dot2_f32_bf16 v24, v144, v4, 0
  v_dot2_f32_bf16 v24, v145, v5, v24
  v_dot2_f32_bf16 v24, v146, v6, v24
  v_dot2_f32_bf16 v24, v147, v7, v24
  s_waitcnt vmcnt(4)
  buffer_load_dwordx4 v[168:171], v2, s[36:39], s48 offen offset:2048 nt
  v_dot2_f32_bf16 v25, v148, v4, 0
  v_dot2_f32_bf16 v25, v149, v5, v25
  v_dot2_f32_bf16 v25, v150, v6, v25
  v_dot2_f32_bf16 v25, v151, v7, v25
  s_waitcnt vmcnt(4)
  buffer_load_dwordx4 v[172:175], v2, s[36:39], s48 offen offset:3072 nt
  v_dot2_f32_bf16 v26, v152, v4, 0
  v_dot2_f32_bf16 v26, v153, v5, v26
  v_dot2_f32_bf16 v26, v154, v6, v26
  v_dot2_f32_bf16 v26, v155, v7, v26
  s_waitcnt vmcnt(4)
  s_mov_b32 s48, 458752
  buffer_load_dwordx4 v[176:179], v2, s[36:39], s48 offen offset:0 nt
  v_dot2_f32_bf16 v27, v156, v4, 0
  v_dot2_f32_bf16 v27, v157, v5, v27
  v_dot2_f32_bf16 v27, v158, v6, v27
  v_dot2_f32_bf16 v27, v159, v7, v27
  s_waitcnt vmcnt(4)
  buffer_load_dwordx4 v[180:183], v2, s[36:39], s48 offen offset:1024 nt
  v_dot2_f32_bf16 v28, v160, v4, 0
  v_dot2_f32_bf16 v28, v161, v5, v28
  v_dot2_f32_bf16 v28, v162, v6, v28
  v_dot2_f32_bf16 v28, v163, v7, v28
  s_waitcnt vmcnt(4)
  buffer_load_dwordx4 v[184:187], v2, s[36:39], s48 offen offset:2048 nt
  v_dot2_f32_bf16 v29, v164, v4, 0
  v_dot2_f32_bf16 v29, v165, v5, v29
  v_dot2_f32_bf16 v29, v166, v6, v29
  v_dot2_f32_bf16 v29, v167, v7, v29
  s_waitcnt vmcnt(4)
  buffer_load_dwordx4 v[188:191], v2, s[36:39], s48 offen offset:3072 nt
  v_dot2_f32_bf16 v30, v168, v4, 0
  v_dot2_f32_bf16 v30, v169, v5, v30
  v_dot2_f32_bf16 v30, v170, v6, v30
  v_dot2_f32_bf16 v30, v171, v7, v30
  s_waitcnt vmcnt(4)
  s_mov_b32 s48, 475136
  buffer_load_dwordx4 v[192:195], v2, s[36:39], s48 offen offset:0 nt
  v_dot2_f32_bf16 v31, v172, v4, 0
  v_dot2_f32_bf16 v31, v173, v5, v31
  v_dot2_f32_bf16 v31, v174, v6, v31
  v_dot2_f32_bf16 v31, v175, v7, v31
  v_add_f32_dpp v16, v16, v16 row_ror:8 row_mask:0xf bank_mask:0x3
  v_add_f32_dpp v17, v17, v17 row_ror:8 row_mask:0xf bank_mask:0x3
  v_add_f32_dpp v18, v18, v18 row_ror:8 row_mask:0xf bank_mask:0x3
  v_add_f32_dpp v19, v19, v19 row_ror:8 row_mask:0xf bank_mask:0x3
  v_add_f32_dpp v20, v20, v20 row_ror:8 row_mask:0xf bank_mask:0x3
  v_add_f32_dpp v21, v21, v21 row_ror:8 row_mask:0xf bank_mask:0x3
  v_add_f32_dpp v22, v22, v22 row_ror:8 row_mask:0xf bank_mask:0x3
  v_add_f32_dpp v23, v23, v23 row_ror:8 row_mask:0xf bank_mask:0x3
  v_add_f32_dpp v16, v24, v24 row_ror:8 row_mask:0xf bank_mask:0xc
  v_add_f32_dpp v17, v25, v25 row_ror:8 row_mask:0xf bank_mask:0xc
  v_add_f32_dpp v18, v26, v26 row_ror:8 row_mask:0xf bank_mask:0xc
  v_add_f32_dpp v19, v27, v27 row_ror:8 row_mask:0xf bank_mask:0xc
  v_add_f32_dpp v20, v28, v28 row_ror:8 row_mask:0xf bank_mask:0xc
  v_add_f32_dpp v21, v29, v29 row_ror:8 row_mask:0xf bank_mask:0xc
  v_add_f32_dpp v22, v30, v30 row_ror:8 row_mask:0xf bank_mask:0xc
  v_add_f32_dpp v23, v31, v31 row_ror:8 row_mask:0xf bank_mask:0xc
  v_add_f32_dpp v16, v16, v16 row_half_mirror row_mask:0xf bank_mask:0x5
  v_add_f32_dpp v17, v17, v17 row_half_mirror row_mask:0xf bank_mask:0x5
  v_add_f32_dpp v18, v18, v18 row_half_mirror row_mask:0xf bank_mask:0x5
  v_add_f32_dpp v19, v19, v19 row_half_mirror row_mask:0xf bank_mask:0x5
  v_add_f32_dpp v16, v20, v20 row_half_mirror row_mask:0xf bank_mask:0xa
  v_add_f32_dpp v17, v21, v21 row_half_mirror row_mask:0xf bank_mask:0xa
  v_add_f32_dpp v18, v22, v22 row_half_mirror row_mask:0xf bank_mask:0xa
  v_add_f32_dpp v19, v23, v23 row_half_mirror row_mask:0xf bank_mask:0xa
  v_add_f32_dpp v16, v16, v16 quad_perm:[1,0,3,2] row_mask:0xf bank_mask:0xf
  v_add_f32_dpp v17, v17, v17 quad_perm:[1,0,3,2] row_mask:0xf bank_mask:0xf
  v_add_f32_dpp v18, v18, v18 quad_perm:[1,0,3,2] row_mask:0xf bank_mask:0xf
  v_add_f32_dpp v19, v19, v19 quad_perm:[1,0,3,2] row_mask:0xf bank_mask:0xf
  v_add_f32_dpp v56, v16, v16 quad_perm:[2,3,0,1] row_mask:0xf bank_mask:0xf
  v_add_f32_dpp v57, v17, v17 quad_perm:[2,3,0,1] row_mask:0xf bank_mask:0xf
  v_add_f32_dpp v58, v18, v18 quad_perm:[2,3,0,1] row_mask:0xf bank_mask:0xf
  v_add_f32_dpp v59, v19, v19 quad_perm:[2,3,0,1] row_mask:0xf bank_mask:0xf
  v_max3_f32 v72, v72, v56, v57
  v_max3_f32 v72, v72, v58, v59
  s_waitcnt vmcnt(4)
  buffer_load_dwordx4 v[196:199], v2, s[36:39], s48 offen offset:1024 nt
  v_dot2_f32_bf16 v16, v176, v4, 0
  v_dot2_f32_bf16 v16, v177, v5, v16
  v_dot2_f32_bf16 v16, v178, v6, v16
  v_dot2_f32_bf16 v16, v179, v7, v16
  s_waitcnt vmcnt(4)
  buffer_load_dwordx4 v[200:203], v2, s[36:39], s48 offen offset:2048 nt
  v_dot2_f32_bf16 v17, v180, v4, 0
  v_dot2_f32_bf16 v17, v181, v5, v17
  v_dot2_f32_bf16 v17, v182, v6, v17
  v_dot2_f32_bf16 v17, v183, v7, v17
  s_waitcnt vmcnt(4)
  buffer_load_dwordx4 v[204:207], v2, s[36:39], s48 offen offset:3072 nt
  v_dot2_f32_bf16 v18, v184, v4, 0
  v_dot2_f32_bf16 v18, v185, v5, v18
  v_dot2_f32_bf16 v18, v186, v6, v18
  v_dot2_f32_bf16 v18, v187, v7, v18
  s_waitcnt vmcnt(4)
  s_mov_b32 s48, 491520
  buffer_load_dwordx4 v[208:211], v2, s[36:39], s48 offen offset:0 nt
  v_dot2_f32_bf16 v19, v188, v4, 0
  v_dot2_f32_bf16 v19, v189, v5, v19
  v_dot2_f32_bf16 v19, v190, v6, v19
  v_dot2_f32_bf16 v19, v191, v7, v19
  s_waitcnt vmcnt(4)
  buffer_load_dwordx4 v[212:215], v2, s[36:39], s48 offen offset:1024 nt
  v_dot2_f32_bf16 v20, v192, v4, 0
  v_dot2_f32_bf16 v20, v193, v5, v20
  v_dot2_f32_bf16 v20, v194, v6, v20
  v_dot2_f32_bf16 v20, v195, v7, v20
  s_waitcnt vmcnt(4)
  buffer_load_dwordx4 v[216:219], v2, s[36:39], s48 offen offset:2048 nt
  v_dot2_f32_bf16 v21, v196, v4, 0
  v_dot2_f32_bf16 v21, v197, v5, v21
  v_dot2_f32_bf16 v21, v198, v6, v21
  v_dot2_f32_bf16 v21, v199, v7, v21
  s_waitcnt vmcnt(4)
  buffer_load_dwordx4 v[220:223], v2, s[36:39], s48 offen offset:3072 nt
  v_dot2_f32_bf16 v22, v200, v4, 0
  v_dot2_f32_bf16 v22, v201, v5, v22
  v_dot2_f32_bf16 v22, v202, v6, v22
  v_dot2_f32_bf16 v22, v203, v7, v22
  s_waitcnt vmcnt(4)
  s_mov_b32 s48, 507904
  buffer_load_dwordx4 v[224:227], v2, s[36:39], s48 offen offset:0 nt
  v_dot2_f32_bf16 v23, v204, v4, 0
  v_dot2_f32_bf16 v23, v205, v5, v23
  v_dot2_f32_bf16 v23, v206, v6, v23
  v_dot2_f32_bf16 v23, v207, v7, v23
  s_waitcnt vmcnt(4)
  buffer_load_dwordx4 v[228:231], v2, s[36:39], s48 offen offset:1024 nt
  v_dot2_f32_bf16 v24, v208, v4, 0
  v_dot2_f32_bf16 v24, v209, v5, v24
  v_dot2_f32_bf16 v24, v210, v6, v24
  v_dot2_f32_bf16 v24, v211, v7, v24
  s_waitcnt vmcnt(4)
  buffer_load_dwordx4 v[232:235], v2, s[36:39], s48 offen offset:2048 nt
  v_dot2_f32_bf16 v25, v212, v4, 0
  v_dot2_f32_bf16 v25, v213, v5, v25
  v_dot2_f32_bf16 v25, v214, v6, v25
  v_dot2_f32_bf16 v25, v215, v7, v25
  s_waitcnt vmcnt(4)
  buffer_load_dwordx4 v[236:239], v2, s[36:39], s48 offen offset:3072 nt
  v_dot2_f32_bf16 v26, v216, v4, 0
  v_dot2_f32_bf16 v26, v217, v5, v26
  v_dot2_f32_bf16 v26, v218, v6, v26
  v_dot2_f32_bf16 v26, v219, v7, v26
  s_waitcnt vmcnt(4)
  s_mov_b32 s48, 0
  buffer_load_dwordx4 v[240:243], v2, s[40:43], s48 offen offset:0 nt
  v_dot2_f32_bf16 v27, v220, v4, 0
  v_dot2_f32_bf16 v27, v221, v5, v27
  v_dot2_f32_bf16 v27, v222, v6, v27
  v_dot2_f32_bf16 v27, v223, v7, v27
  s_waitcnt vmcnt(4)
  buffer_load_dwordx4 v[244:247], v2, s[40:43], s48 offen offset:1024 nt
  v_dot2_f32_bf16 v28, v224, v4, 0
  v_dot2_f32_bf16 v28, v225, v5, v28
  v_dot2_f32_bf16 v28, v226, v6, v28
  v_dot2_f32_bf16 v28, v227, v7, v28
  s_waitcnt vmcnt(4)
  buffer_load_dwordx4 v[248:251], v2, s[40:43], s48 offen offset:2048 nt
  v_dot2_f32_bf16 v29, v228, v4, 0
  v_dot2_f32_bf16 v29, v229, v5, v29
  v_dot2_f32_bf16 v29, v230, v6, v29
  v_dot2_f32_bf16 v29, v231, v7, v29
  s_waitcnt vmcnt(4)
  buffer_load_dwordx4 v[252:255], v2, s[40:43], s48 offen offset:3072 nt
  v_dot2_f32_bf16 v30, v232, v4, 0
  v_dot2_f32_bf16 v30, v233, v5, v30
  v_dot2_f32_bf16 v30, v234, v6, v30
  v_dot2_f32_bf16 v30, v235, v7, v30
  s_waitcnt vmcnt(4)
  s_mov_b32 s48, 16384
  buffer_load_dwordx4 v[80:83], v2, s[40:43], s48 offen offset:0 nt
  v_dot2_f32_bf16 v31, v236, v4, 0
  v_dot2_f32_bf16 v31, v237, v5, v31
  v_dot2_f32_bf16 v31, v238, v6, v31
  v_dot2_f32_bf16 v31, v239, v7, v31
  v_add_f32_dpp v16, v16, v16 row_ror:8 row_mask:0xf bank_mask:0x3
  v_add_f32_dpp v17, v17, v17 row_ror:8 row_mask:0xf bank_mask:0x3
  v_add_f32_dpp v18, v18, v18 row_ror:8 row_mask:0xf bank_mask:0x3
  v_add_f32_dpp v19, v19, v19 row_ror:8 row_mask:0xf bank_mask:0x3
  v_add_f32_dpp v20, v20, v20 row_ror:8 row_mask:0xf bank_mask:0x3
  v_add_f32_dpp v21, v21, v21 row_ror:8 row_mask:0xf bank_mask:0x3
  v_add_f32_dpp v22, v22, v22 row_ror:8 row_mask:0xf bank_mask:0x3
  v_add_f32_dpp v23, v23, v23 row_ror:8 row_mask:0xf bank_mask:0x3
  v_add_f32_dpp v16, v24, v24 row_ror:8 row_mask:0xf bank_mask:0xc
  v_add_f32_dpp v17, v25, v25 row_ror:8 row_mask:0xf bank_mask:0xc
  v_add_f32_dpp v18, v26, v26 row_ror:8 row_mask:0xf bank_mask:0xc
  v_add_f32_dpp v19, v27, v27 row_ror:8 row_mask:0xf bank_mask:0xc
  v_add_f32_dpp v20, v28, v28 row_ror:8 row_mask:0xf bank_mask:0xc
  v_add_f32_dpp v21, v29, v29 row_ror:8 row_mask:0xf bank_mask:0xc
  v_add_f32_dpp v22, v30, v30 row_ror:8 row_mask:0xf bank_mask:0xc
  v_add_f32_dpp v23, v31, v31 row_ror:8 row_mask:0xf bank_mask:0xc
  v_add_f32_dpp v16, v16, v16 row_half_mirror row_mask:0xf bank_mask:0x5
  v_add_f32_dpp v17, v17, v17 row_half_mirror row_mask:0xf bank_mask:0x5
  v_add_f32_dpp v18, v18, v18 row_half_mirror row_mask:0xf bank_mask:0x5
  v_add_f32_dpp v19, v19, v19 row_half_mirror row_mask:0xf bank_mask:0x5
  v_add_f32_dpp v16, v20, v20 row_half_mirror row_mask:0xf bank_mask:0xa
  v_add_f32_dpp v17, v21, v21 row_half_mirror row_mask:0xf bank_mask:0xa
  v_add_f32_dpp v18, v22, v22 row_half_mirror row_mask:0xf bank_mask:0xa
  v_add_f32_dpp v19, v23, v23 row_half_mirror row_mask:0xf bank_mask:0xa
  v_add_f32_dpp v16, v16, v16 quad_perm:[1,0,3,2] row_mask:0xf bank_mask:0xf
  v_add_f32_dpp v17, v17, v17 quad_perm:[1,0,3,2] row_mask:0xf bank_mask:0xf
  v_add_f32_dpp v18, v18, v18 quad_perm:[1,0,3,2] row_mask:0xf bank_mask:0xf
  v_add_f32_dpp v19, v19, v19 quad_perm:[1,0,3,2] row_mask:0xf bank_mask:0xf
  v_add_f32_dpp v60, v16, v16 quad_perm:[2,3,0,1] row_mask:0xf bank_mask:0xf
  v_add_f32_dpp v61, v17, v17 quad_perm:[2,3,0,1] row_mask:0xf bank_mask:0xf
  v_add_f32_dpp v62, v18, v18 quad_perm:[2,3,0,1] row_mask:0xf bank_mask:0xf
  v_add_f32_dpp v63, v19, v19 quad_perm:[2,3,0,1] row_mask:0xf bank_mask:0xf
  v_max3_f32 v72, v72, v60, v61
  v_max3_f32 v72, v72, v62, v63
  s_nop 1
  v_max_f32_dpp v72, v72, v72 row_ror:4 row_mask:0xf bank_mask:0xf
  s_nop 1
  v_max_f32_dpp v72, v72, v72 row_ror:8 row_mask:0xf bank_mask:0xf
  v_mov_b32 v76, v72
  s_nop 1
  v_permlane16_swap_b32 v76, v72
  v_max_f32 v72, v72, v76
  v_mov_b32 v76, v72
  s_nop 1
  v_permlane32_swap_b32 v76, v72
  v_max_f32 v72, v72, v76
  s_mov_b32 s58, 0x3db504f3
  v_cvt_pk_bf16_f32 v72, v72, v72
  v_and_b32 v72, 0xffff0000, v72
  v_mul_f32 v72, s58, v72
  v_cvt_pk_bf16_f32 v72, v72, v72
  v_and_b32 v72, 0xffff0000, v72
  v_mul_f32 v74, s54, v72
  v_cvt_pk_bf16_f32 v78, v32, v33
  v_cvt_pk_bf16_f32 v79, v34, v35
  v_lshlrev_b32 v32, 16, v78
  v_and_b32 v33, 0xffff0000, v78
  v_lshlrev_b32 v34, 16, v79
  v_and_b32 v35, 0xffff0000, v79
  v_mul_f32 v32, s58, v32
  v_mul_f32 v33, s58, v33
  v_mul_f32 v34, s58, v34
  v_mul_f32 v35, s58, v35
  v_cvt_pk_bf16_f32 v78, v32, v33
  v_cvt_pk_bf16_f32 v79, v34, v35
  v_lshlrev_b32 v32, 16, v78
  v_and_b32 v33, 0xffff0000, v78
  v_lshlrev_b32 v34, 16, v79
  v_and_b32 v35, 0xffff0000, v79
  v_fma_f32 v32, v32, s54, -v74
  v_fma_f32 v33, v33, s54, -v74
  v_fma_f32 v34, v34, s54, -v74
  v_fma_f32 v35, v35, s54, -v74
  v_exp_f32 v32, v32
  v_exp_f32 v33, v33
  v_exp_f32 v34, v34
  v_exp_f32 v35, v35
  v_add_f32 v73, v73, v32
  v_add_f32 v73, v73, v33
  v_add_f32 v73, v73, v34
  v_add_f32 v73, v73, v35
  v_cvt_pk_bf16_f32 v32, v32, v32
  v_cvt_pk_bf16_f32 v33, v33, v33
  v_cvt_pk_bf16_f32 v34, v34, v34
  v_cvt_pk_bf16_f32 v35, v35, v35
  v_and_b32_dpp v64, v32, v8 row_newbcast:0 row_mask:0xf bank_mask:0xf
  v_and_b32_dpp v65, v32, v9 row_newbcast:0 row_mask:0xf bank_mask:0xf
  v_and_b32_dpp v66, v32, v10 row_newbcast:0 row_mask:0xf bank_mask:0xf
  v_and_b32_dpp v67, v32, v11 row_newbcast:0 row_mask:0xf bank_mask:0xf
  s_waitcnt vmcnt(4)
  buffer_load_dwordx4 v[84:87], v2, s[40:43], s48 offen offset:1024 nt
  buffer_load_dwordx4 v[88:91], v2, s[40:43], s48 offen offset:2048 nt
  v_mfma_f32_16x16x32_bf16 v[12:15], v[240:243], v[64:67], v[12:15]
  v_and_b32_dpp v68, v33, v8 row_newbcast:0 row_mask:0xf bank_mask:0xf
  v_and_b32_dpp v69, v33, v9 row_newbcast:0 row_mask:0xf bank_mask:0xf
  v_and_b32_dpp v70, v33, v10 row_newbcast:0 row_mask:0xf bank_mask:0xf
  v_and_b32_dpp v71, v33, v11 row_newbcast:0 row_mask:0xf bank_mask:0xf
  v_cvt_pk_bf16_f32 v78, v36, v37
  v_cvt_pk_bf16_f32 v79, v38, v39
  v_lshlrev_b32 v36, 16, v78
  v_and_b32 v37, 0xffff0000, v78
  v_lshlrev_b32 v38, 16, v79
  v_and_b32 v39, 0xffff0000, v79
  s_waitcnt vmcnt(5)
  buffer_load_dwordx4 v[92:95], v2, s[40:43], s48 offen offset:3072 nt
  v_mfma_f32_16x16x32_bf16 v[12:15], v[244:247], v[68:71], v[12:15]
  v_and_b32_dpp v64, v34, v8 row_newbcast:0 row_mask:0xf bank_mask:0xf
  v_and_b32_dpp v65, v34, v9 row_newbcast:0 row_mask:0xf bank_mask:0xf
  v_and_b32_dpp v66, v34, v10 row_newbcast:0 row_mask:0xf bank_mask:0xf
  v_and_b32_dpp v67, v34, v11 row_newbcast:0 row_mask:0xf bank_mask:0xf
  v_mul_f32 v36, s58, v36
  v_mul_f32 v37, s58, v37
  v_mul_f32 v38, s58, v38
  v_mul_f32 v39, s58, v39
  v_cvt_pk_bf16_f32 v78, v36, v37
  v_cvt_pk_bf16_f32 v79, v38, v39
  s_waitcnt vmcnt(5)
  s_mov_b32 s48, 32768
  buffer_load_dwordx4 v[96:99], v2, s[40:43], s48 offen offset:0 nt
  v_mfma_f32_16x16x32_bf16 v[12:15], v[248:251], v[64:67], v[12:15]
  v_and_b32_dpp v68, v35, v8 row_newbcast:0 row_mask:0xf bank_mask:0xf
  v_and_b32_dpp v69, v35, v9 row_newbcast:0 row_mask:0xf bank_mask:0xf
  v_and_b32_dpp v70, v35, v10 row_newbcast:0 row_mask:0xf bank_mask:0xf
  v_and_b32_dpp v71, v35, v11 row_newbcast:0 row_mask:0xf bank_mask:0xf
  v_lshlrev_b32 v36, 16, v78
  v_and_b32 v37, 0xffff0000, v78
  v_lshlrev_b32 v38, 16, v79
  v_and_b32 v39, 0xffff0000, v79
  v_fma_f32 v36, v36, s54, -v74
  v_fma_f32 v37, v37, s54, -v74
  s_waitcnt vmcnt(5)
  buffer_load_dwordx4 v[100:103], v2, s[40:43], s48 offen offset:1024 nt
  v_mfma_f32_16x16x32_bf16 v[12:15], v[252:255], v[68:71], v[12:15]
  v_and_b32_dpp v64, v32, v8 row_newbcast:4 row_mask:0xf bank_mask:0xf
  v_and_b32_dpp v65, v32, v9 row_newbcast:4 row_mask:0xf bank_mask:0xf
  v_and_b32_dpp v66, v32, v10 row_newbcast:4 row_mask:0xf bank_mask:0xf
  v_and_b32_dpp v67, v32, v11 row_newbcast:4 row_mask:0xf bank_mask:0xf
  v_fma_f32 v38, v38, s54, -v74
  v_fma_f32 v39, v39, s54, -v74
  v_exp_f32 v36, v36
  v_exp_f32 v37, v37
  v_exp_f32 v38, v38
  v_exp_f32 v39, v39
  s_waitcnt vmcnt(5)
  buffer_load_dwordx4 v[104:107], v2, s[40:43], s48 offen offset:2048 nt
  v_mfma_f32_16x16x32_bf16 v[12:15], v[80:83], v[64:67], v[12:15]
  v_and_b32_dpp v68, v33, v8 row_newbcast:4 row_mask:0xf bank_mask:0xf
  v_and_b32_dpp v69, v33, v9 row_newbcast:4 row_mask:0xf bank_mask:0xf
  v_and_b32_dpp v70, v33, v10 row_newbcast:4 row_mask:0xf bank_mask:0xf
  v_and_b32_dpp v71, v33, v11 row_newbcast:4 row_mask:0xf bank_mask:0xf
  v_add_f32 v73, v73, v36
  v_add_f32 v73, v73, v37
  v_add_f32 v73, v73, v38
  v_add_f32 v73, v73, v39
  v_cvt_pk_bf16_f32 v36, v36, v36
  v_cvt_pk_bf16_f32 v37, v37, v37
  s_waitcnt vmcnt(5)
  buffer_load_dwordx4 v[108:111], v2, s[40:43], s48 offen offset:3072 nt
  v_mfma_f32_16x16x32_bf16 v[12:15], v[84:87], v[68:71], v[12:15]
  v_and_b32_dpp v64, v34, v8 row_newbcast:4 row_mask:0xf bank_mask:0xf
  v_and_b32_dpp v65, v34, v9 row_newbcast:4 row_mask:0xf bank_mask:0xf
  v_and_b32_dpp v66, v34, v10 row_newbcast:4 row_mask:0xf bank_mask:0xf
  v_and_b32_dpp v67, v34, v11 row_newbcast:4 row_mask:0xf bank_mask:0xf
  v_cvt_pk_bf16_f32 v38, v38, v38
  v_cvt_pk_bf16_f32 v39, v39, v39
  v_cvt_pk_bf16_f32 v78, v40, v41
  v_cvt_pk_bf16_f32 v79, v42, v43
  v_lshlrev_b32 v40, 16, v78
  v_and_b32 v41, 0xffff0000, v78
  s_waitcnt vmcnt(5)
  s_mov_b32 s48, 49152
  buffer_load_dwordx4 v[112:115], v2, s[40:43], s48 offen offset:0 nt
  v_mfma_f32_16x16x32_bf16 v[12:15], v[88:91], v[64:67], v[12:15]
  v_and_b32_dpp v68, v35, v8 row_newbcast:4 row_mask:0xf bank_mask:0xf
  v_and_b32_dpp v69, v35, v9 row_newbcast:4 row_mask:0xf bank_mask:0xf
  v_and_b32_dpp v70, v35, v10 row_newbcast:4 row_mask:0xf bank_mask:0xf
  v_and_b32_dpp v71, v35, v11 row_newbcast:4 row_mask:0xf bank_mask:0xf
  v_lshlrev_b32 v42, 16, v79
  v_and_b32 v43, 0xffff0000, v79
  v_mul_f32 v40, s58, v40
  v_mul_f32 v41, s58, v41
  v_mul_f32 v42, s58, v42
  v_mul_f32 v43, s58, v43
  s_waitcnt vmcnt(5)
  buffer_load_dwordx4 v[116:119], v2, s[40:43], s48 offen offset:1024 nt
  v_mfma_f32_16x16x32_bf16 v[12:15], v[92:95], v[68:71], v[12:15]
  v_and_b32_dpp v64, v32, v8 row_newbcast:8 row_mask:0xf bank_mask:0xf
  v_and_b32_dpp v65, v32, v9 row_newbcast:8 row_mask:0xf bank_mask:0xf
  v_and_b32_dpp v66, v32, v10 row_newbcast:8 row_mask:0xf bank_mask:0xf
  v_and_b32_dpp v67, v32, v11 row_newbcast:8 row_mask:0xf bank_mask:0xf
  v_cvt_pk_bf16_f32 v78, v40, v41
  v_cvt_pk_bf16_f32 v79, v42, v43
  v_lshlrev_b32 v40, 16, v78
  v_and_b32 v41, 0xffff0000, v78
  v_lshlrev_b32 v42, 16, v79
  v_and_b32 v43, 0xffff0000, v79
  s_waitcnt vmcnt(5)
  buffer_load_dwordx4 v[120:123], v2, s[40:43], s48 offen offset:2048 nt
  v_mfma_f32_16x16x32_bf16 v[12:15], v[96:99], v[64:67], v[12:15]
  v_and_b32_dpp v68, v33, v8 row_newbcast:8 row_mask:0xf bank_mask:0xf
  v_and_b32_dpp v69, v33, v9 row_newbcast:8 row_mask:0xf bank_mask:0xf
  v_and_b32_dpp v70, v33, v10 row_newbcast:8 row_mask:0xf bank_mask:0xf
  v_and_b32_dpp v71, v33, v11 row_newbcast:8 row_mask:0xf bank_mask:0xf
  v_fma_f32 v40, v40, s54, -v74
  v_fma_f32 v41, v41, s54, -v74
  v_fma_f32 v42, v42, s54, -v74
  v_fma_f32 v43, v43, s54, -v74
  v_exp_f32 v40, v40
  v_exp_f32 v41, v41
  s_waitcnt vmcnt(5)
  buffer_load_dwordx4 v[124:127], v2, s[40:43], s48 offen offset:3072 nt
  v_mfma_f32_16x16x32_bf16 v[12:15], v[100:103], v[68:71], v[12:15]
  v_and_b32_dpp v64, v34, v8 row_newbcast:8 row_mask:0xf bank_mask:0xf
  v_and_b32_dpp v65, v34, v9 row_newbcast:8 row_mask:0xf bank_mask:0xf
  v_and_b32_dpp v66, v34, v10 row_newbcast:8 row_mask:0xf bank_mask:0xf
  v_and_b32_dpp v67, v34, v11 row_newbcast:8 row_mask:0xf bank_mask:0xf
  v_exp_f32 v42, v42
  v_exp_f32 v43, v43
  v_add_f32 v73, v73, v40
  v_add_f32 v73, v73, v41
  v_add_f32 v73, v73, v42
  v_add_f32 v73, v73, v43
  s_waitcnt vmcnt(5)
  s_mov_b32 s48, 65536
  buffer_load_dwordx4 v[128:131], v2, s[40:43], s48 offen offset:0 nt
  v_mfma_f32_16x16x32_bf16 v[12:15], v[104:107], v[64:67], v[12:15]
  v_and_b32_dpp v68, v35, v8 row_newbcast:8 row_mask:0xf bank_mask:0xf
  v_and_b32_dpp v69, v35, v9 row_newbcast:8 row_mask:0xf bank_mask:0xf
  v_and_b32_dpp v70, v35, v10 row_newbcast:8 row_mask:0xf bank_mask:0xf
  v_and_b32_dpp v71, v35, v11 row_newbcast:8 row_mask:0xf bank_mask:0xf
  v_cvt_pk_bf16_f32 v40, v40, v40
  v_cvt_pk_bf16_f32 v41, v41, v41
  v_cvt_pk_bf16_f32 v42, v42, v42
  v_cvt_pk_bf16_f32 v43, v43, v43
  v_cvt_pk_bf16_f32 v78, v44, v45
  v_cvt_pk_bf16_f32 v79, v46, v47
  s_waitcnt vmcnt(5)
  buffer_load_dwordx4 v[132:135], v2, s[40:43], s48 offen offset:1024 nt
  v_mfma_f32_16x16x32_bf16 v[12:15], v[108:111], v[68:71], v[12:15]
  v_and_b32_dpp v64, v32, v8 row_newbcast:12 row_mask:0xf bank_mask:0xf
  v_and_b32_dpp v65, v32, v9 row_newbcast:12 row_mask:0xf bank_mask:0xf
  v_and_b32_dpp v66, v32, v10 row_newbcast:12 row_mask:0xf bank_mask:0xf
  v_and_b32_dpp v67, v32, v11 row_newbcast:12 row_mask:0xf bank_mask:0xf
  v_lshlrev_b32 v44, 16, v78
  v_and_b32 v45, 0xffff0000, v78
  v_lshlrev_b32 v46, 16, v79
  v_and_b32 v47, 0xffff0000, v79
  v_mul_f32 v44, s58, v44
  v_mul_f32 v45, s58, v45
  s_waitcnt vmcnt(5)
  buffer_load_dwordx4 v[136:139], v2, s[40:43], s48 offen offset:2048 nt
  v_mfma_f32_16x16x32_bf16 v[12:15], v[112:115], v[64:67], v[12:15]
  v_and_b32_dpp v68, v33, v8 row_newbcast:12 row_mask:0xf bank_mask:0xf
  v_and_b32_dpp v69, v33, v9 row_newbcast:12 row_mask:0xf bank_mask:0xf
  v_and_b32_dpp v70, v33, v10 row_newbcast:12 row_mask:0xf bank_mask:0xf
  v_and_b32_dpp v71, v33, v11 row_newbcast:12 row_mask:0xf bank_mask:0xf
  v_mul_f32 v46, s58, v46
  v_mul_f32 v47, s58, v47
  v_cvt_pk_bf16_f32 v78, v44, v45
  v_cvt_pk_bf16_f32 v79, v46, v47
  v_lshlrev_b32 v44, 16, v78
  v_and_b32 v45, 0xffff0000, v78
  s_waitcnt vmcnt(5)
  buffer_load_dwordx4 v[140:143], v2, s[40:43], s48 offen offset:3072 nt
  v_mfma_f32_16x16x32_bf16 v[12:15], v[116:119], v[68:71], v[12:15]
  v_and_b32_dpp v64, v34, v8 row_newbcast:12 row_mask:0xf bank_mask:0xf
  v_and_b32_dpp v65, v34, v9 row_newbcast:12 row_mask:0xf bank_mask:0xf
  v_and_b32_dpp v66, v34, v10 row_newbcast:12 row_mask:0xf bank_mask:0xf
  v_and_b32_dpp v67, v34, v11 row_newbcast:12 row_mask:0xf bank_mask:0xf
  v_lshlrev_b32 v46, 16, v79
  v_and_b32 v47, 0xffff0000, v79
  v_fma_f32 v44, v44, s54, -v74
  v_fma_f32 v45, v45, s54, -v74
  v_fma_f32 v46, v46, s54, -v74
  v_fma_f32 v47, v47, s54, -v74
  s_waitcnt vmcnt(5)
  s_mov_b32 s48, 81920
  buffer_load_dwordx4 v[144:147], v2, s[40:43], s48 offen offset:0 nt
  v_mfma_f32_16x16x32_bf16 v[12:15], v[120:123], v[64:67], v[12:15]
  v_and_b32_dpp v68, v35, v8 row_newbcast:12 row_mask:0xf bank_mask:0xf
  v_and_b32_dpp v69, v35, v9 row_newbcast:12 row_mask:0xf bank_mask:0xf
  v_and_b32_dpp v70, v35, v10 row_newbcast:12 row_mask:0xf bank_mask:0xf
  v_and_b32_dpp v71, v35, v11 row_newbcast:12 row_mask:0xf bank_mask:0xf
  v_exp_f32 v44, v44
  v_exp_f32 v45, v45
  v_exp_f32 v46, v46
  v_exp_f32 v47, v47
  v_add_f32 v73, v73, v44
  v_add_f32 v73, v73, v45
  s_waitcnt vmcnt(5)
  buffer_load_dwordx4 v[148:151], v2, s[40:43], s48 offen offset:1024 nt
  v_mfma_f32_16x16x32_bf16 v[12:15], v[124:127], v[68:71], v[12:15]
  v_and_b32_dpp v64, v36, v8 row_newbcast:0 row_mask:0xf bank_mask:0xf
  v_and_b32_dpp v65, v36, v9 row_newbcast:0 row_mask:0xf bank_mask:0xf
  v_and_b32_dpp v66, v36, v10 row_newbcast:0 row_mask:0xf bank_mask:0xf
  v_and_b32_dpp v67, v36, v11 row_newbcast:0 row_mask:0xf bank_mask:0xf
  v_add_f32 v73, v73, v46
  v_add_f32 v73, v73, v47
  v_cvt_pk_bf16_f32 v44, v44, v44
  v_cvt_pk_bf16_f32 v45, v45, v45
  v_cvt_pk_bf16_f32 v46, v46, v46
  v_cvt_pk_bf16_f32 v47, v47, v47
  s_waitcnt vmcnt(5)
  buffer_load_dwordx4 v[152:155], v2, s[40:43], s48 offen offset:2048 nt
  v_mfma_f32_16x16x32_bf16 v[12:15], v[128:131], v[64:67], v[12:15]
  v_and_b32_dpp v68, v37, v8 row_newbcast:0 row_mask:0xf bank_mask:0xf
  v_and_b32_dpp v69, v37, v9 row_newbcast:0 row_mask:0xf bank_mask:0xf
  v_and_b32_dpp v70, v37, v10 row_newbcast:0 row_mask:0xf bank_mask:0xf
  v_and_b32_dpp v71, v37, v11 row_newbcast:0 row_mask:0xf bank_mask:0xf
  v_cvt_pk_bf16_f32 v78, v48, v49
  v_cvt_pk_bf16_f32 v79, v50, v51
  v_lshlrev_b32 v48, 16, v78
  v_and_b32 v49, 0xffff0000, v78
  v_lshlrev_b32 v50, 16, v79
  v_and_b32 v51, 0xffff0000, v79
  s_waitcnt vmcnt(5)
  buffer_load_dwordx4 v[156:159], v2, s[40:43], s48 offen offset:3072 nt
  v_mfma_f32_16x16x32_bf16 v[12:15], v[132:135], v[68:71], v[12:15]
  v_and_b32_dpp v64, v38, v8 row_newbcast:0 row_mask:0xf bank_mask:0xf
  v_and_b32_dpp v65, v38, v9 row_newbcast:0 row_mask:0xf bank_mask:0xf
  v_and_b32_dpp v66, v38, v10 row_newbcast:0 row_mask:0xf bank_mask:0xf
  v_and_b32_dpp v67, v38, v11 row_newbcast:0 row_mask:0xf bank_mask:0xf
  v_mul_f32 v48, s58, v48
  v_mul_f32 v49, s58, v49
  v_mul_f32 v50, s58, v50
  v_mul_f32 v51, s58, v51
  v_cvt_pk_bf16_f32 v78, v48, v49
  v_cvt_pk_bf16_f32 v79, v50, v51
  s_waitcnt vmcnt(5)
  s_mov_b32 s48, 98304
  buffer_load_dwordx4 v[160:163], v2, s[40:43], s48 offen offset:0 nt
  v_mfma_f32_16x16x32_bf16 v[12:15], v[136:139], v[64:67], v[12:15]
  v_and_b32_dpp v68, v39, v8 row_newbcast:0 row_mask:0xf bank_mask:0xf
  v_and_b32_dpp v69, v39, v9 row_newbcast:0 row_mask:0xf bank_mask:0xf
  v_and_b32_dpp v70, v39, v10 row_newbcast:0 row_mask:0xf bank_mask:0xf
  v_and_b32_dpp v71, v39, v11 row_newbcast:0 row_mask:0xf bank_mask:0xf
  v_lshlrev_b32 v48, 16, v78
  v_and_b32 v49, 0xffff0000, v78
  v_lshlrev_b32 v50, 16, v79
  v_and_b32 v51, 0xffff0000, v79
  v_fma_f32 v48, v48, s54, -v74
  v_fma_f32 v49, v49, s54, -v74
  s_waitcnt vmcnt(5)
  buffer_load_dwordx4 v[164:167], v2, s[40:43], s48 offen offset:1024 nt
  v_mfma_f32_16x16x32_bf16 v[12:15], v[140:143], v[68:71], v[12:15]
  v_and_b32_dpp v64, v36, v8 row_newbcast:4 row_mask:0xf bank_mask:0xf
  v_and_b32_dpp v65, v36, v9 row_newbcast:4 row_mask:0xf bank_mask:0xf
  v_and_b32_dpp v66, v36, v10 row_newbcast:4 row_mask:0xf bank_mask:0xf
  v_and_b32_dpp v67, v36, v11 row_newbcast:4 row_mask:0xf bank_mask:0xf
  v_fma_f32 v50, v50, s54, -v74
  v_fma_f32 v51, v51, s54, -v74
  v_exp_f32 v48, v48
  v_exp_f32 v49, v49
  v_exp_f32 v50, v50
  v_exp_f32 v51, v51
  s_waitcnt vmcnt(5)
  buffer_load_dwordx4 v[168:171], v2, s[40:43], s48 offen offset:2048 nt
  v_mfma_f32_16x16x32_bf16 v[12:15], v[144:147], v[64:67], v[12:15]
  v_and_b32_dpp v68, v37, v8 row_newbcast:4 row_mask:0xf bank_mask:0xf
  v_and_b32_dpp v69, v37, v9 row_newbcast:4 row_mask:0xf bank_mask:0xf
  v_and_b32_dpp v70, v37, v10 row_newbcast:4 row_mask:0xf bank_mask:0xf
  v_and_b32_dpp v71, v37, v11 row_newbcast:4 row_mask:0xf bank_mask:0xf
  v_add_f32 v73, v73, v48
  v_add_f32 v73, v73, v49
  v_add_f32 v73, v73, v50
  v_add_f32 v73, v73, v51
  v_cvt_pk_bf16_f32 v48, v48, v48
  v_cvt_pk_bf16_f32 v49, v49, v49
  s_waitcnt vmcnt(5)
  buffer_load_dwordx4 v[172:175], v2, s[40:43], s48 offen offset:3072 nt
  v_mfma_f32_16x16x32_bf16 v[12:15], v[148:151], v[68:71], v[12:15]
  v_and_b32_dpp v64, v38, v8 row_newbcast:4 row_mask:0xf bank_mask:0xf
  v_and_b32_dpp v65, v38, v9 row_newbcast:4 row_mask:0xf bank_mask:0xf
  v_and_b32_dpp v66, v38, v10 row_newbcast:4 row_mask:0xf bank_mask:0xf
  v_and_b32_dpp v67, v38, v11 row_newbcast:4 row_mask:0xf bank_mask:0xf
  v_cvt_pk_bf16_f32 v50, v50, v50
  v_cvt_pk_bf16_f32 v51, v51, v51
  v_cvt_pk_bf16_f32 v78, v52, v53
  v_cvt_pk_bf16_f32 v79, v54, v55
  v_lshlrev_b32 v52, 16, v78
  v_and_b32 v53, 0xffff0000, v78
  s_waitcnt vmcnt(5)
  s_mov_b32 s48, 114688
  buffer_load_dwordx4 v[176:179], v2, s[40:43], s48 offen offset:0 nt
  v_mfma_f32_16x16x32_bf16 v[12:15], v[152:155], v[64:67], v[12:15]
  v_and_b32_dpp v68, v39, v8 row_newbcast:4 row_mask:0xf bank_mask:0xf
  v_and_b32_dpp v69, v39, v9 row_newbcast:4 row_mask:0xf bank_mask:0xf
  v_and_b32_dpp v70, v39, v10 row_newbcast:4 row_mask:0xf bank_mask:0xf
  v_and_b32_dpp v71, v39, v11 row_newbcast:4 row_mask:0xf bank_mask:0xf
  v_lshlrev_b32 v54, 16, v79
  v_and_b32 v55, 0xffff0000, v79
  v_mul_f32 v52, s58, v52
  v_mul_f32 v53, s58, v53
  v_mul_f32 v54, s58, v54
  v_mul_f32 v55, s58, v55
  s_waitcnt vmcnt(5)
  buffer_load_dwordx4 v[180:183], v2, s[40:43], s48 offen offset:1024 nt
  v_mfma_f32_16x16x32_bf16 v[12:15], v[156:159], v[68:71], v[12:15]
  v_and_b32_dpp v64, v36, v8 row_newbcast:8 row_mask:0xf bank_mask:0xf
  v_and_b32_dpp v65, v36, v9 row_newbcast:8 row_mask:0xf bank_mask:0xf
  v_and_b32_dpp v66, v36, v10 row_newbcast:8 row_mask:0xf bank_mask:0xf
  v_and_b32_dpp v67, v36, v11 row_newbcast:8 row_mask:0xf bank_mask:0xf
  v_cvt_pk_bf16_f32 v78, v52, v53
  v_cvt_pk_bf16_f32 v79, v54, v55
  v_lshlrev_b32 v52, 16, v78
  v_and_b32 v53, 0xffff0000, v78
  v_lshlrev_b32 v54, 16, v79
  v_and_b32 v55, 0xffff0000, v79
  s_waitcnt vmcnt(5)
  buffer_load_dwordx4 v[184:187], v2, s[40:43], s48 offen offset:2048 nt
  v_mfma_f32_16x16x32_bf16 v[12:15], v[160:163], v[64:67], v[12:15]
  v_and_b32_dpp v68, v37, v8 row_newbcast:8 row_mask:0xf bank_mask:0xf
  v_and_b32_dpp v69, v37, v9 row_newbcast:8 row_mask:0xf bank_mask:0xf
  v_and_b32_dpp v70, v37, v10 row_newbcast:8 row_mask:0xf bank_mask:0xf
  v_and_b32_dpp v71, v37, v11 row_newbcast:8 row_mask:0xf bank_mask:0xf
  v_fma_f32 v52, v52, s54, -v74
  v_fma_f32 v53, v53, s54, -v74
  v_fma_f32 v54, v54, s54, -v74
  v_fma_f32 v55, v55, s54, -v74
  v_exp_f32 v52, v52
  v_exp_f32 v53, v53
  s_waitcnt vmcnt(5)
  buffer_load_dwordx4 v[188:191], v2, s[40:43], s48 offen offset:3072 nt
  v_mfma_f32_16x16x32_bf16 v[12:15], v[164:167], v[68:71], v[12:15]
  v_and_b32_dpp v64, v38, v8 row_newbcast:8 row_mask:0xf bank_mask:0xf
  v_and_b32_dpp v65, v38, v9 row_newbcast:8 row_mask:0xf bank_mask:0xf
  v_and_b32_dpp v66, v38, v10 row_newbcast:8 row_mask:0xf bank_mask:0xf
  v_and_b32_dpp v67, v38, v11 row_newbcast:8 row_mask:0xf bank_mask:0xf
  v_exp_f32 v54, v54
  v_exp_f32 v55, v55
  v_add_f32 v73, v73, v52
  v_add_f32 v73, v73, v53
  v_add_f32 v73, v73, v54
  v_add_f32 v73, v73, v55
  s_waitcnt vmcnt(5)
  s_mov_b32 s48, 131072
  buffer_load_dwordx4 v[192:195], v2, s[40:43], s48 offen offset:0 nt
  v_mfma_f32_16x16x32_bf16 v[12:15], v[168:171], v[64:67], v[12:15]
  v_and_b32_dpp v68, v39, v8 row_newbcast:8 row_mask:0xf bank_mask:0xf
  v_and_b32_dpp v69, v39, v9 row_newbcast:8 row_mask:0xf bank_mask:0xf
  v_and_b32_dpp v70, v39, v10 row_newbcast:8 row_mask:0xf bank_mask:0xf
  v_and_b32_dpp v71, v39, v11 row_newbcast:8 row_mask:0xf bank_mask:0xf
  v_cvt_pk_bf16_f32 v52, v52, v52
  v_cvt_pk_bf16_f32 v53, v53, v53
  v_cvt_pk_bf16_f32 v54, v54, v54
  v_cvt_pk_bf16_f32 v55, v55, v55
  v_cvt_pk_bf16_f32 v78, v56, v57
  v_cvt_pk_bf16_f32 v79, v58, v59
  s_waitcnt vmcnt(5)
  buffer_load_dwordx4 v[196:199], v2, s[40:43], s48 offen offset:1024 nt
  v_mfma_f32_16x16x32_bf16 v[12:15], v[172:175], v[68:71], v[12:15]
  v_and_b32_dpp v64, v36, v8 row_newbcast:12 row_mask:0xf bank_mask:0xf
  v_and_b32_dpp v65, v36, v9 row_newbcast:12 row_mask:0xf bank_mask:0xf
  v_and_b32_dpp v66, v36, v10 row_newbcast:12 row_mask:0xf bank_mask:0xf
  v_and_b32_dpp v67, v36, v11 row_newbcast:12 row_mask:0xf bank_mask:0xf
  v_lshlrev_b32 v56, 16, v78
  v_and_b32 v57, 0xffff0000, v78
  v_lshlrev_b32 v58, 16, v79
  v_and_b32 v59, 0xffff0000, v79
  v_mul_f32 v56, s58, v56
  v_mul_f32 v57, s58, v57
  s_waitcnt vmcnt(5)
  buffer_load_dwordx4 v[200:203], v2, s[40:43], s48 offen offset:2048 nt
  v_mfma_f32_16x16x32_bf16 v[12:15], v[176:179], v[64:67], v[12:15]
  v_and_b32_dpp v68, v37, v8 row_newbcast:12 row_mask:0xf bank_mask:0xf
  v_and_b32_dpp v69, v37, v9 row_newbcast:12 row_mask:0xf bank_mask:0xf
  v_and_b32_dpp v70, v37, v10 row_newbcast:12 row_mask:0xf bank_mask:0xf
  v_and_b32_dpp v71, v37, v11 row_newbcast:12 row_mask:0xf bank_mask:0xf
  v_mul_f32 v58, s58, v58
  v_mul_f32 v59, s58, v59
  v_cvt_pk_bf16_f32 v78, v56, v57
  v_cvt_pk_bf16_f32 v79, v58, v59
  v_lshlrev_b32 v56, 16, v78
  v_and_b32 v57, 0xffff0000, v78
  s_waitcnt vmcnt(5)
  buffer_load_dwordx4 v[204:207], v2, s[40:43], s48 offen offset:3072 nt
  v_mfma_f32_16x16x32_bf16 v[12:15], v[180:183], v[68:71], v[12:15]
  v_and_b32_dpp v64, v38, v8 row_newbcast:12 row_mask:0xf bank_mask:0xf
  v_and_b32_dpp v65, v38, v9 row_newbcast:12 row_mask:0xf bank_mask:0xf
  v_and_b32_dpp v66, v38, v10 row_newbcast:12 row_mask:0xf bank_mask:0xf
  v_and_b32_dpp v67, v38, v11 row_newbcast:12 row_mask:0xf bank_mask:0xf
  v_lshlrev_b32 v58, 16, v79
  v_and_b32 v59, 0xffff0000, v79
  v_fma_f32 v56, v56, s54, -v74
  v_fma_f32 v57, v57, s54, -v74
  v_fma_f32 v58, v58, s54, -v74
  v_fma_f32 v59, v59, s54, -v74
  s_waitcnt vmcnt(5)
  s_mov_b32 s48, 147456
  buffer_load_dwordx4 v[208:211], v2, s[40:43], s48 offen offset:0 nt
  v_mfma_f32_16x16x32_bf16 v[12:15], v[184:187], v[64:67], v[12:15]
  v_and_b32_dpp v68, v39, v8 row_newbcast:12 row_mask:0xf bank_mask:0xf
  v_and_b32_dpp v69, v39, v9 row_newbcast:12 row_mask:0xf bank_mask:0xf
  v_and_b32_dpp v70, v39, v10 row_newbcast:12 row_mask:0xf bank_mask:0xf
  v_and_b32_dpp v71, v39, v11 row_newbcast:12 row_mask:0xf bank_mask:0xf
  v_exp_f32 v56, v56
  v_exp_f32 v57, v57
  v_exp_f32 v58, v58
  v_exp_f32 v59, v59
  v_add_f32 v73, v73, v56
  v_add_f32 v73, v73, v57
  s_waitcnt vmcnt(5)
  buffer_load_dwordx4 v[212:215], v2, s[40:43], s48 offen offset:1024 nt
  v_mfma_f32_16x16x32_bf16 v[12:15], v[188:191], v[68:71], v[12:15]
  v_and_b32_dpp v64, v40, v8 row_newbcast:0 row_mask:0xf bank_mask:0xf
  v_and_b32_dpp v65, v40, v9 row_newbcast:0 row_mask:0xf bank_mask:0xf
  v_and_b32_dpp v66, v40, v10 row_newbcast:0 row_mask:0xf bank_mask:0xf
  v_and_b32_dpp v67, v40, v11 row_newbcast:0 row_mask:0xf bank_mask:0xf
  v_add_f32 v73, v73, v58
  v_add_f32 v73, v73, v59
  v_cvt_pk_bf16_f32 v56, v56, v56
  v_cvt_pk_bf16_f32 v57, v57, v57
  v_cvt_pk_bf16_f32 v58, v58, v58
  v_cvt_pk_bf16_f32 v59, v59, v59
  s_waitcnt vmcnt(5)
  buffer_load_dwordx4 v[216:219], v2, s[40:43], s48 offen offset:2048 nt
  v_mfma_f32_16x16x32_bf16 v[12:15], v[192:195], v[64:67], v[12:15]
  v_and_b32_dpp v68, v41, v8 row_newbcast:0 row_mask:0xf bank_mask:0xf
  v_and_b32_dpp v69, v41, v9 row_newbcast:0 row_mask:0xf bank_mask:0xf
  v_and_b32_dpp v70, v41, v10 row_newbcast:0 row_mask:0xf bank_mask:0xf
  v_and_b32_dpp v71, v41, v11 row_newbcast:0 row_mask:0xf bank_mask:0xf
  v_cvt_pk_bf16_f32 v78, v60, v61
  v_cvt_pk_bf16_f32 v79, v62, v63
  v_lshlrev_b32 v60, 16, v78
  v_and_b32 v61, 0xffff0000, v78
  v_lshlrev_b32 v62, 16, v79
  v_and_b32 v63, 0xffff0000, v79
  v_mov_b32 v76, 14224
  v_mov_b32 v77, 2
  s_mov_b64 exec, 1
  ds_max_u32 v76, v77
  s_mov_b64 exec, -1
  s_waitcnt vmcnt(5)
  buffer_load_dwordx4 v[220:223], v2, s[40:43], s48 offen offset:3072 nt
  v_mfma_f32_16x16x32_bf16 v[12:15], v[196:199], v[68:71], v[12:15]
  v_and_b32_dpp v64, v42, v8 row_newbcast:0 row_mask:0xf bank_mask:0xf
  v_and_b32_dpp v65, v42, v9 row_newbcast:0 row_mask:0xf bank_mask:0xf
  v_and_b32_dpp v66, v42, v10 row_newbcast:0 row_mask:0xf bank_mask:0xf
  v_and_b32_dpp v67, v42, v11 row_newbcast:0 row_mask:0xf bank_mask:0xf
  v_mul_f32 v60, s58, v60
  v_mul_f32 v61, s58, v61
  v_mul_f32 v62, s58, v62
  v_mul_f32 v63, s58, v63
  v_cvt_pk_bf16_f32 v78, v60, v61
  v_cvt_pk_bf16_f32 v79, v62, v63
  s_waitcnt vmcnt(5)
  s_mov_b32 s48, 163840
  buffer_load_dwordx4 v[224:227], v2, s[40:43], s48 offen offset:0 nt
  v_mfma_f32_16x16x32_bf16 v[12:15], v[200:203], v[64:67], v[12:15]
  v_and_b32_dpp v68, v43, v8 row_newbcast:0 row_mask:0xf bank_mask:0xf
  v_and_b32_dpp v69, v43, v9 row_newbcast:0 row_mask:0xf bank_mask:0xf
  v_and_b32_dpp v70, v43, v10 row_newbcast:0 row_mask:0xf bank_mask:0xf
  v_and_b32_dpp v71, v43, v11 row_newbcast:0 row_mask:0xf bank_mask:0xf
  v_lshlrev_b32 v60, 16, v78
  v_and_b32 v61, 0xffff0000, v78
  v_lshlrev_b32 v62, 16, v79
  v_and_b32 v63, 0xffff0000, v79
  v_fma_f32 v60, v60, s54, -v74
  v_fma_f32 v61, v61, s54, -v74
  s_waitcnt vmcnt(5)
  buffer_load_dwordx4 v[228:231], v2, s[40:43], s48 offen offset:1024 nt
  v_mfma_f32_16x16x32_bf16 v[12:15], v[204:207], v[68:71], v[12:15]
  v_and_b32_dpp v64, v40, v8 row_newbcast:4 row_mask:0xf bank_mask:0xf
  v_and_b32_dpp v65, v40, v9 row_newbcast:4 row_mask:0xf bank_mask:0xf
  v_and_b32_dpp v66, v40, v10 row_newbcast:4 row_mask:0xf bank_mask:0xf
  v_and_b32_dpp v67, v40, v11 row_newbcast:4 row_mask:0xf bank_mask:0xf
  v_fma_f32 v62, v62, s54, -v74
  v_fma_f32 v63, v63, s54, -v74
  v_exp_f32 v60, v60
  v_exp_f32 v61, v61
  v_exp_f32 v62, v62
  v_exp_f32 v63, v63
  s_waitcnt vmcnt(5)
  buffer_load_dwordx4 v[232:235], v2, s[40:43], s48 offen offset:2048 nt
  v_mfma_f32_16x16x32_bf16 v[12:15], v[208:211], v[64:67], v[12:15]
  v_and_b32_dpp v68, v41, v8 row_newbcast:4 row_mask:0xf bank_mask:0xf
  v_and_b32_dpp v69, v41, v9 row_newbcast:4 row_mask:0xf bank_mask:0xf
  v_and_b32_dpp v70, v41, v10 row_newbcast:4 row_mask:0xf bank_mask:0xf
  v_and_b32_dpp v71, v41, v11 row_newbcast:4 row_mask:0xf bank_mask:0xf
  v_add_f32 v73, v73, v60
  v_add_f32 v73, v73, v61
  v_add_f32 v73, v73, v62
  v_add_f32 v73, v73, v63
  v_cvt_pk_bf16_f32 v60, v60, v60
  v_cvt_pk_bf16_f32 v61, v61, v61
  s_waitcnt vmcnt(5)
  buffer_load_dwordx4 v[236:239], v2, s[40:43], s48 offen offset:3072 nt
  v_mfma_f32_16x16x32_bf16 v[12:15], v[212:215], v[68:71], v[12:15]
  v_and_b32_dpp v64, v42, v8 row_newbcast:4 row_mask:0xf bank_mask:0xf
  v_and_b32_dpp v65, v42, v9 row_newbcast:4 row_mask:0xf bank_mask:0xf
  v_and_b32_dpp v66, v42, v10 row_newbcast:4 row_mask:0xf bank_mask:0xf
  v_and_b32_dpp v67, v42, v11 row_newbcast:4 row_mask:0xf bank_mask:0xf
  v_cvt_pk_bf16_f32 v62, v62, v62
  v_cvt_pk_bf16_f32 v63, v63, v63
  v_add_f32_dpp v73, v73, v73 row_ror:8 row_mask:0xf bank_mask:0xf
  s_nop 1
  v_add_f32_dpp v73, v73, v73 row_ror:4 row_mask:0xf bank_mask:0xf
  s_nop 1
  v_add_f32_dpp v73, v73, v73 row_ror:2 row_mask:0xf bank_mask:0xf
  s_nop 1
  v_add_f32_dpp v73, v73, v73 row_ror:1 row_mask:0xf bank_mask:0xf
  v_mov_b32 v76, v73
  s_nop 1
  v_permlane16_swap_b32 v76, v73
  v_add_f32 v73, v73, v76
  v_mov_b32 v76, v73
  s_nop 1
  v_permlane32_swap_b32 v76, v73
  v_add_f32 v73, v73, v76
  v_mul_f32 v73, 0.25, v73
  v_mov_b32 v78, v74
  v_mov_b32 v79, v73
  s_lshl_b32 s49, s33, 3
  s_add_u32 s49, s49, 14144
  v_mov_b32 v77, s49
  ds_write_b64 v77, v[78:79]
  s_waitcnt vmcnt(5)
  s_mov_b32 s48, 180224
  buffer_load_dwordx4 v[240:243], v2, s[40:43], s48 offen offset:0 nt
  v_mfma_f32_16x16x32_bf16 v[12:15], v[216:219], v[64:67], v[12:15]
  v_and_b32_dpp v68, v43, v8 row_newbcast:4 row_mask:0xf bank_mask:0xf
  v_and_b32_dpp v69, v43, v9 row_newbcast:4 row_mask:0xf bank_mask:0xf
  v_and_b32_dpp v70, v43, v10 row_newbcast:4 row_mask:0xf bank_mask:0xf
  v_and_b32_dpp v71, v43, v11 row_newbcast:4 row_mask:0xf bank_mask:0xf
  s_waitcnt vmcnt(5)
  buffer_load_dwordx4 v[244:247], v2, s[40:43], s48 offen offset:1024 nt
  v_mfma_f32_16x16x32_bf16 v[12:15], v[220:223], v[68:71], v[12:15]
  v_and_b32_dpp v64, v40, v8 row_newbcast:8 row_mask:0xf bank_mask:0xf
  v_and_b32_dpp v65, v40, v9 row_newbcast:8 row_mask:0xf bank_mask:0xf
  v_and_b32_dpp v66, v40, v10 row_newbcast:8 row_mask:0xf bank_mask:0xf
  v_and_b32_dpp v67, v40, v11 row_newbcast:8 row_mask:0xf bank_mask:0xf
  s_waitcnt vmcnt(5)
  buffer_load_dwordx4 v[248:251], v2, s[40:43], s48 offen offset:2048 nt
  v_mfma_f32_16x16x32_bf16 v[12:15], v[224:227], v[64:67], v[12:15]
  v_and_b32_dpp v68, v41, v8 row_newbcast:8 row_mask:0xf bank_mask:0xf
  v_and_b32_dpp v69, v41, v9 row_newbcast:8 row_mask:0xf bank_mask:0xf
  v_and_b32_dpp v70, v41, v10 row_newbcast:8 row_mask:0xf bank_mask:0xf
  v_and_b32_dpp v71, v41, v11 row_newbcast:8 row_mask:0xf bank_mask:0xf
  s_waitcnt vmcnt(5)
  buffer_load_dwordx4 v[252:255], v2, s[40:43], s48 offen offset:3072 nt
  v_mfma_f32_16x16x32_bf16 v[12:15], v[228:231], v[68:71], v[12:15]
  v_and_b32_dpp v64, v42, v8 row_newbcast:8 row_mask:0xf bank_mask:0xf
  v_and_b32_dpp v65, v42, v9 row_newbcast:8 row_mask:0xf bank_mask:0xf
  v_and_b32_dpp v66, v42, v10 row_newbcast:8 row_mask:0xf bank_mask:0xf
  v_and_b32_dpp v67, v42, v11 row_newbcast:8 row_mask:0xf bank_mask:0xf
  s_waitcnt vmcnt(5)
  s_mov_b32 s48, 196608
  buffer_load_dwordx4 v[80:83], v2, s[40:43], s48 offen offset:0 nt
  v_mfma_f32_16x16x32_bf16 v[12:15], v[232:235], v[64:67], v[12:15]
  v_and_b32_dpp v68, v43, v8 row_newbcast:8 row_mask:0xf bank_mask:0xf
  v_and_b32_dpp v69, v43, v9 row_newbcast:8 row_mask:0xf bank_mask:0xf
  v_and_b32_dpp v70, v43, v10 row_newbcast:8 row_mask:0xf bank_mask:0xf
  v_and_b32_dpp v71, v43, v11 row_newbcast:8 row_mask:0xf bank_mask:0xf
  s_waitcnt vmcnt(5)
  buffer_load_dwordx4 v[84:87], v2, s[40:43], s48 offen offset:1024 nt
  v_mfma_f32_16x16x32_bf16 v[12:15], v[236:239], v[68:71], v[12:15]
  v_and_b32_dpp v64, v40, v8 row_newbcast:12 row_mask:0xf bank_mask:0xf
  v_and_b32_dpp v65, v40, v9 row_newbcast:12 row_mask:0xf bank_mask:0xf
  v_and_b32_dpp v66, v40, v10 row_newbcast:12 row_mask:0xf bank_mask:0xf
  v_and_b32_dpp v67, v40, v11 row_newbcast:12 row_mask:0xf bank_mask:0xf
  s_waitcnt vmcnt(5)
  buffer_load_dwordx4 v[88:91], v2, s[40:43], s48 offen offset:2048 nt
  v_mfma_f32_16x16x32_bf16 v[12:15], v[240:243], v[64:67], v[12:15]
  v_and_b32_dpp v68, v41, v8 row_newbcast:12 row_mask:0xf bank_mask:0xf
  v_and_b32_dpp v69, v41, v9 row_newbcast:12 row_mask:0xf bank_mask:0xf
  v_and_b32_dpp v70, v41, v10 row_newbcast:12 row_mask:0xf bank_mask:0xf
  v_and_b32_dpp v71, v41, v11 row_newbcast:12 row_mask:0xf bank_mask:0xf
  s_waitcnt vmcnt(5)
  buffer_load_dwordx4 v[92:95], v2, s[40:43], s48 offen offset:3072 nt
  v_mfma_f32_16x16x32_bf16 v[12:15], v[244:247], v[68:71], v[12:15]
  v_and_b32_dpp v64, v42, v8 row_newbcast:12 row_mask:0xf bank_mask:0xf
  v_and_b32_dpp v65, v42, v9 row_newbcast:12 row_mask:0xf bank_mask:0xf
  v_and_b32_dpp v66, v42, v10 row_newbcast:12 row_mask:0xf bank_mask:0xf
  v_and_b32_dpp v67, v42, v11 row_newbcast:12 row_mask:0xf bank_mask:0xf
  s_waitcnt vmcnt(5)
  s_mov_b32 s48, 212992
  buffer_load_dwordx4 v[96:99], v2, s[40:43], s48 offen offset:0 nt
  v_mfma_f32_16x16x32_bf16 v[12:15], v[248:251], v[64:67], v[12:15]
  v_and_b32_dpp v68, v43, v8 row_newbcast:12 row_mask:0xf bank_mask:0xf
  v_and_b32_dpp v69, v43, v9 row_newbcast:12 row_mask:0xf bank_mask:0xf
  v_and_b32_dpp v70, v43, v10 row_newbcast:12 row_mask:0xf bank_mask:0xf
  v_and_b32_dpp v71, v43, v11 row_newbcast:12 row_mask:0xf bank_mask:0xf
  s_waitcnt vmcnt(5)
  buffer_load_dwordx4 v[100:103], v2, s[40:43], s48 offen offset:1024 nt
  v_mfma_f32_16x16x32_bf16 v[12:15], v[252:255], v[68:71], v[12:15]
  v_and_b32_dpp v64, v44, v8 row_newbcast:0 row_mask:0xf bank_mask:0xf
  v_and_b32_dpp v65, v44, v9 row_newbcast:0 row_mask:0xf bank_mask:0xf
  v_and_b32_dpp v66, v44, v10 row_newbcast:0 row_mask:0xf bank_mask:0xf
  v_and_b32_dpp v67, v44, v11 row_newbcast:0 row_mask:0xf bank_mask:0xf
  s_waitcnt vmcnt(5)
  buffer_load_dwordx4 v[104:107], v2, s[40:43], s48 offen offset:2048 nt
  v_mfma_f32_16x16x32_bf16 v[12:15], v[80:83], v[64:67], v[12:15]
  v_and_b32_dpp v68, v45, v8 row_newbcast:0 row_mask:0xf bank_mask:0xf
  v_and_b32_dpp v69, v45, v9 row_newbcast:0 row_mask:0xf bank_mask:0xf
  v_and_b32_dpp v70, v45, v10 row_newbcast:0 row_mask:0xf bank_mask:0xf
  v_and_b32_dpp v71, v45, v11 row_newbcast:0 row_mask:0xf bank_mask:0xf
  s_waitcnt vmcnt(5)
  buffer_load_dwordx4 v[108:111], v2, s[40:43], s48 offen offset:3072 nt
  v_mfma_f32_16x16x32_bf16 v[12:15], v[84:87], v[68:71], v[12:15]
  v_and_b32_dpp v64, v46, v8 row_newbcast:0 row_mask:0xf bank_mask:0xf
  v_and_b32_dpp v65, v46, v9 row_newbcast:0 row_mask:0xf bank_mask:0xf
  v_and_b32_dpp v66, v46, v10 row_newbcast:0 row_mask:0xf bank_mask:0xf
  v_and_b32_dpp v67, v46, v11 row_newbcast:0 row_mask:0xf bank_mask:0xf
  s_waitcnt vmcnt(5)
  s_mov_b32 s48, 229376
  buffer_load_dwordx4 v[112:115], v2, s[40:43], s48 offen offset:0 nt
  v_mfma_f32_16x16x32_bf16 v[12:15], v[88:91], v[64:67], v[12:15]
  v_and_b32_dpp v68, v47, v8 row_newbcast:0 row_mask:0xf bank_mask:0xf
  v_and_b32_dpp v69, v47, v9 row_newbcast:0 row_mask:0xf bank_mask:0xf
  v_and_b32_dpp v70, v47, v10 row_newbcast:0 row_mask:0xf bank_mask:0xf
  v_and_b32_dpp v71, v47, v11 row_newbcast:0 row_mask:0xf bank_mask:0xf
  s_waitcnt vmcnt(5)
  buffer_load_dwordx4 v[116:119], v2, s[40:43], s48 offen offset:1024 nt
  v_mfma_f32_16x16x32_bf16 v[12:15], v[92:95], v[68:71], v[12:15]
  v_and_b32_dpp v64, v44, v8 row_newbcast:4 row_mask:0xf bank_mask:0xf
  v_and_b32_dpp v65, v44, v9 row_newbcast:4 row_mask:0xf bank_mask:0xf
  v_and_b32_dpp v66, v44, v10 row_newbcast:4 row_mask:0xf bank_mask:0xf
  v_and_b32_dpp v67, v44, v11 row_newbcast:4 row_mask:0xf bank_mask:0xf
  s_waitcnt vmcnt(5)
  buffer_load_dwordx4 v[120:123], v2, s[40:43], s48 offen offset:2048 nt
  v_mfma_f32_16x16x32_bf16 v[12:15], v[96:99], v[64:67], v[12:15]
  v_and_b32_dpp v68, v45, v8 row_newbcast:4 row_mask:0xf bank_mask:0xf
  v_and_b32_dpp v69, v45, v9 row_newbcast:4 row_mask:0xf bank_mask:0xf
  v_and_b32_dpp v70, v45, v10 row_newbcast:4 row_mask:0xf bank_mask:0xf
  v_and_b32_dpp v71, v45, v11 row_newbcast:4 row_mask:0xf bank_mask:0xf
  s_waitcnt vmcnt(5)
  buffer_load_dwordx4 v[124:127], v2, s[40:43], s48 offen offset:3072 nt
  v_mfma_f32_16x16x32_bf16 v[12:15], v[100:103], v[68:71], v[12:15]
  v_and_b32_dpp v64, v46, v8 row_newbcast:4 row_mask:0xf bank_mask:0xf
  v_and_b32_dpp v65, v46, v9 row_newbcast:4 row_mask:0xf bank_mask:0xf
  v_and_b32_dpp v66, v46, v10 row_newbcast:4 row_mask:0xf bank_mask:0xf
  v_and_b32_dpp v67, v46, v11 row_newbcast:4 row_mask:0xf bank_mask:0xf
  s_waitcnt vmcnt(5)
  s_mov_b32 s48, 245760
  buffer_load_dwordx4 v[128:131], v2, s[40:43], s48 offen offset:0 nt
  v_mfma_f32_16x16x32_bf16 v[12:15], v[104:107], v[64:67], v[12:15]
  v_and_b32_dpp v68, v47, v8 row_newbcast:4 row_mask:0xf bank_mask:0xf
  v_and_b32_dpp v69, v47, v9 row_newbcast:4 row_mask:0xf bank_mask:0xf
  v_and_b32_dpp v70, v47, v10 row_newbcast:4 row_mask:0xf bank_mask:0xf
  v_and_b32_dpp v71, v47, v11 row_newbcast:4 row_mask:0xf bank_mask:0xf
  s_waitcnt vmcnt(5)
  buffer_load_dwordx4 v[132:135], v2, s[40:43], s48 offen offset:1024 nt
  v_mfma_f32_16x16x32_bf16 v[12:15], v[108:111], v[68:71], v[12:15]
  v_and_b32_dpp v64, v44, v8 row_newbcast:8 row_mask:0xf bank_mask:0xf
  v_and_b32_dpp v65, v44, v9 row_newbcast:8 row_mask:0xf bank_mask:0xf
  v_and_b32_dpp v66, v44, v10 row_newbcast:8 row_mask:0xf bank_mask:0xf
  v_and_b32_dpp v67, v44, v11 row_newbcast:8 row_mask:0xf bank_mask:0xf
  s_waitcnt vmcnt(5)
  buffer_load_dwordx4 v[136:139], v2, s[40:43], s48 offen offset:2048 nt
  v_mfma_f32_16x16x32_bf16 v[12:15], v[112:115], v[64:67], v[12:15]
  v_and_b32_dpp v68, v45, v8 row_newbcast:8 row_mask:0xf bank_mask:0xf
  v_and_b32_dpp v69, v45, v9 row_newbcast:8 row_mask:0xf bank_mask:0xf
  v_and_b32_dpp v70, v45, v10 row_newbcast:8 row_mask:0xf bank_mask:0xf
  v_and_b32_dpp v71, v45, v11 row_newbcast:8 row_mask:0xf bank_mask:0xf
  s_waitcnt vmcnt(5)
  buffer_load_dwordx4 v[140:143], v2, s[40:43], s48 offen offset:3072 nt
  v_mfma_f32_16x16x32_bf16 v[12:15], v[116:119], v[68:71], v[12:15]
  v_and_b32_dpp v64, v46, v8 row_newbcast:8 row_mask:0xf bank_mask:0xf
  v_and_b32_dpp v65, v46, v9 row_newbcast:8 row_mask:0xf bank_mask:0xf
  v_and_b32_dpp v66, v46, v10 row_newbcast:8 row_mask:0xf bank_mask:0xf
  v_and_b32_dpp v67, v46, v11 row_newbcast:8 row_mask:0xf bank_mask:0xf
  s_waitcnt vmcnt(5)
  s_mov_b32 s48, 262144
  buffer_load_dwordx4 v[144:147], v2, s[40:43], s48 offen offset:0 nt
  v_mfma_f32_16x16x32_bf16 v[12:15], v[120:123], v[64:67], v[12:15]
  v_and_b32_dpp v68, v47, v8 row_newbcast:8 row_mask:0xf bank_mask:0xf
  v_and_b32_dpp v69, v47, v9 row_newbcast:8 row_mask:0xf bank_mask:0xf
  v_and_b32_dpp v70, v47, v10 row_newbcast:8 row_mask:0xf bank_mask:0xf
  v_and_b32_dpp v71, v47, v11 row_newbcast:8 row_mask:0xf bank_mask:0xf
  s_waitcnt vmcnt(5)
  buffer_load_dwordx4 v[148:151], v2, s[40:43], s48 offen offset:1024 nt
  v_mfma_f32_16x16x32_bf16 v[12:15], v[124:127], v[68:71], v[12:15]
  v_and_b32_dpp v64, v44, v8 row_newbcast:12 row_mask:0xf bank_mask:0xf
  v_and_b32_dpp v65, v44, v9 row_newbcast:12 row_mask:0xf bank_mask:0xf
  v_and_b32_dpp v66, v44, v10 row_newbcast:12 row_mask:0xf bank_mask:0xf
  v_and_b32_dpp v67, v44, v11 row_newbcast:12 row_mask:0xf bank_mask:0xf
  s_waitcnt vmcnt(5)
  buffer_load_dwordx4 v[152:155], v2, s[40:43], s48 offen offset:2048 nt
  v_mfma_f32_16x16x32_bf16 v[12:15], v[128:131], v[64:67], v[12:15]
  v_and_b32_dpp v68, v45, v8 row_newbcast:12 row_mask:0xf bank_mask:0xf
  v_and_b32_dpp v69, v45, v9 row_newbcast:12 row_mask:0xf bank_mask:0xf
  v_and_b32_dpp v70, v45, v10 row_newbcast:12 row_mask:0xf bank_mask:0xf
  v_and_b32_dpp v71, v45, v11 row_newbcast:12 row_mask:0xf bank_mask:0xf
  s_waitcnt vmcnt(5)
  buffer_load_dwordx4 v[156:159], v2, s[40:43], s48 offen offset:3072 nt
  v_mfma_f32_16x16x32_bf16 v[12:15], v[132:135], v[68:71], v[12:15]
  v_and_b32_dpp v64, v46, v8 row_newbcast:12 row_mask:0xf bank_mask:0xf
  v_and_b32_dpp v65, v46, v9 row_newbcast:12 row_mask:0xf bank_mask:0xf
  v_and_b32_dpp v66, v46, v10 row_newbcast:12 row_mask:0xf bank_mask:0xf
  v_and_b32_dpp v67, v46, v11 row_newbcast:12 row_mask:0xf bank_mask:0xf
  s_waitcnt vmcnt(5)
  s_mov_b32 s48, 278528
  buffer_load_dwordx4 v[160:163], v2, s[40:43], s48 offen offset:0 nt
  v_mfma_f32_16x16x32_bf16 v[12:15], v[136:139], v[64:67], v[12:15]
  v_and_b32_dpp v68, v47, v8 row_newbcast:12 row_mask:0xf bank_mask:0xf
  v_and_b32_dpp v69, v47, v9 row_newbcast:12 row_mask:0xf bank_mask:0xf
  v_and_b32_dpp v70, v47, v10 row_newbcast:12 row_mask:0xf bank_mask:0xf
  v_and_b32_dpp v71, v47, v11 row_newbcast:12 row_mask:0xf bank_mask:0xf
  s_waitcnt vmcnt(5)
  buffer_load_dwordx4 v[164:167], v2, s[40:43], s48 offen offset:1024 nt
  v_mfma_f32_16x16x32_bf16 v[12:15], v[140:143], v[68:71], v[12:15]
  v_and_b32_dpp v64, v48, v8 row_newbcast:0 row_mask:0xf bank_mask:0xf
  v_and_b32_dpp v65, v48, v9 row_newbcast:0 row_mask:0xf bank_mask:0xf
  v_and_b32_dpp v66, v48, v10 row_newbcast:0 row_mask:0xf bank_mask:0xf
  v_and_b32_dpp v67, v48, v11 row_newbcast:0 row_mask:0xf bank_mask:0xf
  s_waitcnt vmcnt(5)
  buffer_load_dwordx4 v[168:171], v2, s[40:43], s48 offen offset:2048 nt
  v_mfma_f32_16x16x32_bf16 v[12:15], v[144:147], v[64:67], v[12:15]
  v_and_b32_dpp v68, v49, v8 row_newbcast:0 row_mask:0xf bank_mask:0xf
  v_and_b32_dpp v69, v49, v9 row_newbcast:0 row_mask:0xf bank_mask:0xf
  v_and_b32_dpp v70, v49, v10 row_newbcast:0 row_mask:0xf bank_mask:0xf
  v_and_b32_dpp v71, v49, v11 row_newbcast:0 row_mask:0xf bank_mask:0xf
  v_mov_b32 v76, 14224
  v_mov_b32 v77, 3
  s_mov_b64 exec, 1
  ds_max_u32 v76, v77
  s_mov_b64 exec, -1
  s_waitcnt vmcnt(5)
  buffer_load_dwordx4 v[172:175], v2, s[40:43], s48 offen offset:3072 nt
  v_mfma_f32_16x16x32_bf16 v[12:15], v[148:151], v[68:71], v[12:15]
  v_and_b32_dpp v64, v50, v8 row_newbcast:0 row_mask:0xf bank_mask:0xf
  v_and_b32_dpp v65, v50, v9 row_newbcast:0 row_mask:0xf bank_mask:0xf
  v_and_b32_dpp v66, v50, v10 row_newbcast:0 row_mask:0xf bank_mask:0xf
  v_and_b32_dpp v67, v50, v11 row_newbcast:0 row_mask:0xf bank_mask:0xf
  s_waitcnt vmcnt(5)
  s_mov_b32 s48, 294912
  buffer_load_dwordx4 v[176:179], v2, s[40:43], s48 offen offset:0 nt
  v_mfma_f32_16x16x32_bf16 v[12:15], v[152:155], v[64:67], v[12:15]
  v_and_b32_dpp v68, v51, v8 row_newbcast:0 row_mask:0xf bank_mask:0xf
  v_and_b32_dpp v69, v51, v9 row_newbcast:0 row_mask:0xf bank_mask:0xf
  v_and_b32_dpp v70, v51, v10 row_newbcast:0 row_mask:0xf bank_mask:0xf
  v_and_b32_dpp v71, v51, v11 row_newbcast:0 row_mask:0xf bank_mask:0xf
  s_waitcnt vmcnt(5)
  buffer_load_dwordx4 v[180:183], v2, s[40:43], s48 offen offset:1024 nt
  v_mfma_f32_16x16x32_bf16 v[12:15], v[156:159], v[68:71], v[12:15]
  v_and_b32_dpp v64, v48, v8 row_newbcast:4 row_mask:0xf bank_mask:0xf
  v_and_b32_dpp v65, v48, v9 row_newbcast:4 row_mask:0xf bank_mask:0xf
  v_and_b32_dpp v66, v48, v10 row_newbcast:4 row_mask:0xf bank_mask:0xf
  v_and_b32_dpp v67, v48, v11 row_newbcast:4 row_mask:0xf bank_mask:0xf
  s_waitcnt vmcnt(5)
  buffer_load_dwordx4 v[184:187], v2, s[40:43], s48 offen offset:2048 nt
  v_mfma_f32_16x16x32_bf16 v[12:15], v[160:163], v[64:67], v[12:15]
  v_and_b32_dpp v68, v49, v8 row_newbcast:4 row_mask:0xf bank_mask:0xf
  v_and_b32_dpp v69, v49, v9 row_newbcast:4 row_mask:0xf bank_mask:0xf
  v_and_b32_dpp v70, v49, v10 row_newbcast:4 row_mask:0xf bank_mask:0xf
  v_and_b32_dpp v71, v49, v11 row_newbcast:4 row_mask:0xf bank_mask:0xf
  s_waitcnt vmcnt(5)
  buffer_load_dwordx4 v[188:191], v2, s[40:43], s48 offen offset:3072 nt
  v_mfma_f32_16x16x32_bf16 v[12:15], v[164:167], v[68:71], v[12:15]
  v_and_b32_dpp v64, v50, v8 row_newbcast:4 row_mask:0xf bank_mask:0xf
  v_and_b32_dpp v65, v50, v9 row_newbcast:4 row_mask:0xf bank_mask:0xf
  v_and_b32_dpp v66, v50, v10 row_newbcast:4 row_mask:0xf bank_mask:0xf
  v_and_b32_dpp v67, v50, v11 row_newbcast:4 row_mask:0xf bank_mask:0xf
  s_waitcnt vmcnt(5)
  s_mov_b32 s48, 311296
  buffer_load_dwordx4 v[192:195], v2, s[40:43], s48 offen offset:0 nt
  v_mfma_f32_16x16x32_bf16 v[12:15], v[168:171], v[64:67], v[12:15]
  v_and_b32_dpp v68, v51, v8 row_newbcast:4 row_mask:0xf bank_mask:0xf
  v_and_b32_dpp v69, v51, v9 row_newbcast:4 row_mask:0xf bank_mask:0xf
  v_and_b32_dpp v70, v51, v10 row_newbcast:4 row_mask:0xf bank_mask:0xf
  v_and_b32_dpp v71, v51, v11 row_newbcast:4 row_mask:0xf bank_mask:0xf
  s_waitcnt vmcnt(5)
  buffer_load_dwordx4 v[196:199], v2, s[40:43], s48 offen offset:1024 nt
  v_mfma_f32_16x16x32_bf16 v[12:15], v[172:175], v[68:71], v[12:15]
  v_and_b32_dpp v64, v48, v8 row_newbcast:8 row_mask:0xf bank_mask:0xf
  v_and_b32_dpp v65, v48, v9 row_newbcast:8 row_mask:0xf bank_mask:0xf
  v_and_b32_dpp v66, v48, v10 row_newbcast:8 row_mask:0xf bank_mask:0xf
  v_and_b32_dpp v67, v48, v11 row_newbcast:8 row_mask:0xf bank_mask:0xf
  s_waitcnt vmcnt(5)
  buffer_load_dwordx4 v[200:203], v2, s[40:43], s48 offen offset:2048 nt
  v_mfma_f32_16x16x32_bf16 v[12:15], v[176:179], v[64:67], v[12:15]
  v_and_b32_dpp v68, v49, v8 row_newbcast:8 row_mask:0xf bank_mask:0xf
  v_and_b32_dpp v69, v49, v9 row_newbcast:8 row_mask:0xf bank_mask:0xf
  v_and_b32_dpp v70, v49, v10 row_newbcast:8 row_mask:0xf bank_mask:0xf
  v_and_b32_dpp v71, v49, v11 row_newbcast:8 row_mask:0xf bank_mask:0xf
  v_mov_b32 v76, 14144
  s_mov_b32 s53, 400000
L_stat_1:
  ds_read_b128 v[16:19], v76
  ds_read_b128 v[20:23], v76 offset:16
  s_sub_u32 s53, s53, 1
  s_cbranch_scc1 L_stat_1_x
  s_waitcnt lgkmcnt(0)
  v_max3_u32 v77, v17, v19, v21
  v_max_u32 v77, v77, v23
  v_cmp_eq_u32 vcc, -1, v77
  s_nop 0
  s_cbranch_vccnz L_stat_1
L_stat_1_x:
  s_waitcnt lgkmcnt(0)
  v_max3_f32 v77, v16, v18, v20
  v_max_f32 v77, v77, v22
  v_sub_f32 v75, v74, v77
  v_exp_f32 v75, v75
  v_lshrrev_b32 v78, 4, v1
  v_and_b32 v79, 15, v1
  v_lshl_add_u32 v78, v78, 3, v79
  v_lshlrev_b32 v78, 4, v78
  s_lshl_b32 s49, s33, 9
  s_add_u32 s49, s49, 20992
  v_add_u32 v72, s49, v78
  s_waitcnt vmcnt(5)
  buffer_load_dwordx4 v[204:207], v2, s[40:43], s48 offen offset:3072 nt
  v_mfma_f32_16x16x32_bf16 v[12:15], v[180:183], v[68:71], v[12:15]
  v_and_b32_dpp v64, v50, v8 row_newbcast:8 row_mask:0xf bank_mask:0xf
  v_and_b32_dpp v65, v50, v9 row_newbcast:8 row_mask:0xf bank_mask:0xf
  v_and_b32_dpp v66, v50, v10 row_newbcast:8 row_mask:0xf bank_mask:0xf
  v_and_b32_dpp v67, v50, v11 row_newbcast:8 row_mask:0xf bank_mask:0xf
  s_waitcnt vmcnt(5)
  s_mov_b32 s48, 327680
  buffer_load_dwordx4 v[208:211], v2, s[40:43], s48 offen offset:0 nt
  v_mfma_f32_16x16x32_bf16 v[12:15], v[184:187], v[64:67], v[12:15]
  v_and_b32_dpp v68, v51, v8 row_newbcast:8 row_mask:0xf bank_mask:0xf
  v_and_b32_dpp v69, v51, v9 row_newbcast:8 row_mask:0xf bank_mask:0xf
  v_and_b32_dpp v70, v51, v10 row_newbcast:8 row_mask:0xf bank_mask:0xf
  v_and_b32_dpp v71, v51, v11 row_newbcast:8 row_mask:0xf bank_mask:0xf
  s_waitcnt vmcnt(5)
  buffer_load_dwordx4 v[212:215], v2, s[40:43], s48 offen offset:1024 nt
  v_mfma_f32_16x16x32_bf16 v[12:15], v[188:191], v[68:71], v[12:15]
  v_and_b32_dpp v64, v48, v8 row_newbcast:12 row_mask:0xf bank_mask:0xf
  v_and_b32_dpp v65, v48, v9 row_newbcast:12 row_mask:0xf bank_mask:0xf
  v_and_b32_dpp v66, v48, v10 row_newbcast:12 row_mask:0xf bank_mask:0xf
  v_and_b32_dpp v67, v48, v11 row_newbcast:12 row_mask:0xf bank_mask:0xf
  s_waitcnt vmcnt(5)
  buffer_load_dwordx4 v[216:219], v2, s[40:43], s48 offen offset:2048 nt
  v_mfma_f32_16x16x32_bf16 v[12:15], v[192:195], v[64:67], v[12:15]
  v_and_b32_dpp v68, v49, v8 row_newbcast:12 row_mask:0xf bank_mask:0xf
  v_and_b32_dpp v69, v49, v9 row_newbcast:12 row_mask:0xf bank_mask:0xf
  v_and_b32_dpp v70, v49, v10 row_newbcast:12 row_mask:0xf bank_mask:0xf
  v_and_b32_dpp v71, v49, v11 row_newbcast:12 row_mask:0xf bank_mask:0xf
  s_waitcnt vmcnt(5)
  buffer_load_dwordx4 v[220:223], v2, s[40:43], s48 offen offset:3072 nt
  v_mfma_f32_16x16x32_bf16 v[12:15], v[196:199], v[68:71], v[12:15]
  v_and_b32_dpp v64, v50, v8 row_newbcast:12 row_mask:0xf bank_mask:0xf
  v_and_b32_dpp v65, v50, v9 row_newbcast:12 row_mask:0xf bank_mask:0xf
  v_and_b32_dpp v66, v50, v10 row_newbcast:12 row_mask:0xf bank_mask:0xf
  v_and_b32_dpp v67, v50, v11 row_newbcast:12 row_mask:0xf bank_mask:0xf
  s_waitcnt vmcnt(5)
  s_mov_b32 s48, 344064
  buffer_load_dwordx4 v[224:227], v2, s[40:43], s48 offen offset:0 nt
  v_mfma_f32_16x16x32_bf16 v[12:15], v[200:203], v[64:67], v[12:15]
  v_and_b32_dpp v68, v51, v8 row_newbcast:12 row_mask:0xf bank_mask:0xf
  v_and_b32_dpp v69, v51, v9 row_newbcast:12 row_mask:0xf bank_mask:0xf
  v_and_b32_dpp v70, v51, v10 row_newbcast:12 row_mask:0xf bank_mask:0xf
  v_and_b32_dpp v71, v51, v11 row_newbcast:12 row_mask:0xf bank_mask:0xf
  s_waitcnt vmcnt(5)
  buffer_load_dwordx4 v[228:231], v2, s[40:43], s48 offen offset:1024 nt
  v_mfma_f32_16x16x32_bf16 v[12:15], v[204:207], v[68:71], v[12:15]
  v_and_b32_dpp v64, v52, v8 row_newbcast:0 row_mask:0xf bank_mask:0xf
  v_and_b32_dpp v65, v52, v9 row_newbcast:0 row_mask:0xf bank_mask:0xf
  v_and_b32_dpp v66, v52, v10 row_newbcast:0 row_mask:0xf bank_mask:0xf
  v_and_b32_dpp v67, v52, v11 row_newbcast:0 row_mask:0xf bank_mask:0xf
  s_waitcnt vmcnt(5)
  buffer_load_dwordx4 v[232:235], v2, s[40:43], s48 offen offset:2048 nt
  v_mfma_f32_16x16x32_bf16 v[12:15], v[208:211], v[64:67], v[12:15]
  v_and_b32_dpp v68, v53, v8 row_newbcast:0 row_mask:0xf bank_mask:0xf
  v_and_b32_dpp v69, v53, v9 row_newbcast:0 row_mask:0xf bank_mask:0xf
  v_and_b32_dpp v70, v53, v10 row_newbcast:0 row_mask:0xf bank_mask:0xf
  v_and_b32_dpp v71, v53, v11 row_newbcast:0 row_mask:0xf bank_mask:0xf
  s_waitcnt vmcnt(5)
  buffer_load_dwordx4 v[236:239], v2, s[40:43], s48 offen offset:3072 nt
  v_mfma_f32_16x16x32_bf16 v[12:15], v[212:215], v[68:71], v[12:15]
  v_and_b32_dpp v64, v54, v8 row_newbcast:0 row_mask:0xf bank_mask:0xf
  v_and_b32_dpp v65, v54, v9 row_newbcast:0 row_mask:0xf bank_mask:0xf
  v_and_b32_dpp v66, v54, v10 row_newbcast:0 row_mask:0xf bank_mask:0xf
  v_and_b32_dpp v67, v54, v11 row_newbcast:0 row_mask:0xf bank_mask:0xf
  s_waitcnt vmcnt(5)
  s_mov_b32 s48, 360448
  buffer_load_dwordx4 v[240:243], v2, s[40:43], s48 offen offset:0 nt
  v_mfma_f32_16x16x32_bf16 v[12:15], v[216:219], v[64:67], v[12:15]
  v_and_b32_dpp v68, v55, v8 row_newbcast:0 row_mask:0xf bank_mask:0xf
  v_and_b32_dpp v69, v55, v9 row_newbcast:0 row_mask:0xf bank_mask:0xf
  v_and_b32_dpp v70, v55, v10 row_newbcast:0 row_mask:0xf bank_mask:0xf
  v_and_b32_dpp v71, v55, v11 row_newbcast:0 row_mask:0xf bank_mask:0xf
  s_waitcnt vmcnt(5)
  buffer_load_dwordx4 v[244:247], v2, s[40:43], s48 offen offset:1024 nt
  v_mfma_f32_16x16x32_bf16 v[12:15], v[220:223], v[68:71], v[12:15]
  v_and_b32_dpp v64, v52, v8 row_newbcast:4 row_mask:0xf bank_mask:0xf
  v_and_b32_dpp v65, v52, v9 row_newbcast:4 row_mask:0xf bank_mask:0xf
  v_and_b32_dpp v66, v52, v10 row_newbcast:4 row_mask:0xf bank_mask:0xf
  v_and_b32_dpp v67, v52, v11 row_newbcast:4 row_mask:0xf bank_mask:0xf
  s_waitcnt vmcnt(5)
  buffer_load_dwordx4 v[248:251], v2, s[40:43], s48 offen offset:2048 nt
  v_mfma_f32_16x16x32_bf16 v[12:15], v[224:227], v[64:67], v[12:15]
  v_and_b32_dpp v68, v53, v8 row_newbcast:4 row_mask:0xf bank_mask:0xf
  v_and_b32_dpp v69, v53, v9 row_newbcast:4 row_mask:0xf bank_mask:0xf
  v_and_b32_dpp v70, v53, v10 row_newbcast:4 row_mask:0xf bank_mask:0xf
  v_and_b32_dpp v71, v53, v11 row_newbcast:4 row_mask:0xf bank_mask:0xf
  s_waitcnt vmcnt(5)
  buffer_load_dwordx4 v[252:255], v2, s[40:43], s48 offen offset:3072 nt
  v_mfma_f32_16x16x32_bf16 v[12:15], v[228:231], v[68:71], v[12:15]
  v_and_b32_dpp v64, v54, v8 row_newbcast:4 row_mask:0xf bank_mask:0xf
  v_and_b32_dpp v65, v54, v9 row_newbcast:4 row_mask:0xf bank_mask:0xf
  v_and_b32_dpp v66, v54, v10 row_newbcast:4 row_mask:0xf bank_mask:0xf
  v_and_b32_dpp v67, v54, v11 row_newbcast:4 row_mask:0xf bank_mask:0xf
  s_waitcnt vmcnt(5)
  s_mov_b32 s48, 376832
  buffer_load_dwordx4 v[80:83], v2, s[40:43], s48 offen offset:0 nt
  v_mfma_f32_16x16x32_bf16 v[12:15], v[232:235], v[64:67], v[12:15]
  v_and_b32_dpp v68, v55, v8 row_newbcast:4 row_mask:0xf bank_mask:0xf
  v_and_b32_dpp v69, v55, v9 row_newbcast:4 row_mask:0xf bank_mask:0xf
  v_and_b32_dpp v70, v55, v10 row_newbcast:4 row_mask:0xf bank_mask:0xf
  v_and_b32_dpp v71, v55, v11 row_newbcast:4 row_mask:0xf bank_mask:0xf
  s_waitcnt vmcnt(5)
  buffer_load_dwordx4 v[84:87], v2, s[40:43], s48 offen offset:1024 nt
  v_mfma_f32_16x16x32_bf16 v[12:15], v[236:239], v[68:71], v[12:15]
  v_and_b32_dpp v64, v52, v8 row_newbcast:8 row_mask:0xf bank_mask:0xf
  v_and_b32_dpp v65, v52, v9 row_newbcast:8 row_mask:0xf bank_mask:0xf
  v_and_b32_dpp v66, v52, v10 row_newbcast:8 row_mask:0xf bank_mask:0xf
  v_and_b32_dpp v67, v52, v11 row_newbcast:8 row_mask:0xf bank_mask:0xf
  s_waitcnt vmcnt(5)
  buffer_load_dwordx4 v[88:91], v2, s[40:43], s48 offen offset:2048 nt
  v_mfma_f32_16x16x32_bf16 v[12:15], v[240:243], v[64:67], v[12:15]
  v_and_b32_dpp v68, v53, v8 row_newbcast:8 row_mask:0xf bank_mask:0xf
  v_and_b32_dpp v69, v53, v9 row_newbcast:8 row_mask:0xf bank_mask:0xf
  v_and_b32_dpp v70, v53, v10 row_newbcast:8 row_mask:0xf bank_mask:0xf
  v_and_b32_dpp v71, v53, v11 row_newbcast:8 row_mask:0xf bank_mask:0xf
  s_waitcnt vmcnt(5)
  buffer_load_dwordx4 v[92:95], v2, s[40:43], s48 offen offset:3072 nt
  v_mfma_f32_16x16x32_bf16 v[12:15], v[244:247], v[68:71], v[12:15]
  v_and_b32_dpp v64, v54, v8 row_newbcast:8 row_mask:0xf bank_mask:0xf
  v_and_b32_dpp v65, v54, v9 row_newbcast:8 row_mask:0xf bank_mask:0xf
  v_and_b32_dpp v66, v54, v10 row_newbcast:8 row_mask:0xf bank_mask:0xf
  v_and_b32_dpp v67, v54, v11 row_newbcast:8 row_mask:0xf bank_mask:0xf
  s_waitcnt vmcnt(5)
  s_mov_b32 s48, 393216
  buffer_load_dwordx4 v[96:99], v2, s[40:43], s48 offen offset:0 nt
  v_mfma_f32_16x16x32_bf16 v[12:15], v[248:251], v[64:67], v[12:15]
  v_and_b32_dpp v68, v55, v8 row_newbcast:8 row_mask:0xf bank_mask:0xf
  v_and_b32_dpp v69, v55, v9 row_newbcast:8 row_mask:0xf bank_mask:0xf
  v_and_b32_dpp v70, v55, v10 row_newbcast:8 row_mask:0xf bank_mask:0xf
  v_and_b32_dpp v71, v55, v11 row_newbcast:8 row_mask:0xf bank_mask:0xf
  s_waitcnt vmcnt(5)
  buffer_load_dwordx4 v[100:103], v2, s[40:43], s48 offen offset:1024 nt
  v_mfma_f32_16x16x32_bf16 v[12:15], v[252:255], v[68:71], v[12:15]
  v_and_b32_dpp v64, v52, v8 row_newbcast:12 row_mask:0xf bank_mask:0xf
  v_and_b32_dpp v65, v52, v9 row_newbcast:12 row_mask:0xf bank_mask:0xf
  v_and_b32_dpp v66, v52, v10 row_newbcast:12 row_mask:0xf bank_mask:0xf
  v_and_b32_dpp v67, v52, v11 row_newbcast:12 row_mask:0xf bank_mask:0xf
  s_waitcnt vmcnt(5)
  buffer_load_dwordx4 v[104:107], v2, s[40:43], s48 offen offset:2048 nt
  v_mfma_f32_16x16x32_bf16 v[12:15], v[80:83], v[64:67], v[12:15]
  v_and_b32_dpp v68, v53, v8 row_newbcast:12 row_mask:0xf bank_mask:0xf
  v_and_b32_dpp v69, v53, v9 row_newbcast:12 row_mask:0xf bank_mask:0xf
  v_and_b32_dpp v70, v53, v10 row_newbcast:12 row_mask:0xf bank_mask:0xf
  v_and_b32_dpp v71, v53, v11 row_newbcast:12 row_mask:0xf bank_mask:0xf
  s_waitcnt vmcnt(5)
  buffer_load_dwordx4 v[108:111], v2, s[40:43], s48 offen offset:3072 nt
  v_mfma_f32_16x16x32_bf16 v[12:15], v[84:87], v[68:71], v[12:15]
  v_and_b32_dpp v64, v54, v8 row_newbcast:12 row_mask:0xf bank_mask:0xf
  v_and_b32_dpp v65, v54, v9 row_newbcast:12 row_mask:0xf bank_mask:0xf
  v_and_b32_dpp v66, v54, v10 row_newbcast:12 row_mask:0xf bank_mask:0xf
  v_and_b32_dpp v67, v54, v11 row_newbcast:12 row_mask:0xf bank_mask:0xf
  s_waitcnt vmcnt(5)
  s_mov_b32 s48, 409600
  buffer_load_dwordx4 v[112:115], v2, s[40:43], s48 offen offset:0 nt
  v_mfma_f32_16x16x32_bf16 v[12:15], v[88:91], v[64:67], v[12:15]
  v_and_b32_dpp v68, v55, v8 row_newbcast:12 row_mask:0xf bank_mask:0xf
  v_and_b32_dpp v69, v55, v9 row_newbcast:12 row_mask:0xf bank_mask:0xf
  v_and_b32_dpp v70, v55, v10 row_newbcast:12 row_mask:0xf bank_mask:0xf
  v_and_b32_dpp v71, v55, v11 row_newbcast:12 row_mask:0xf bank_mask:0xf
  s_waitcnt vmcnt(5)
  buffer_load_dwordx4 v[116:119], v2, s[40:43], s48 offen offset:1024 nt
  v_mfma_f32_16x16x32_bf16 v[12:15], v[92:95], v[68:71], v[12:15]
  v_and_b32_dpp v64, v56, v8 row_newbcast:0 row_mask:0xf bank_mask:0xf
  v_and_b32_dpp v65, v56, v9 row_newbcast:0 row_mask:0xf bank_mask:0xf
  v_and_b32_dpp v66, v56, v10 row_newbcast:0 row_mask:0xf bank_mask:0xf
  v_and_b32_dpp v67, v56, v11 row_newbcast:0 row_mask:0xf bank_mask:0xf
  s_waitcnt vmcnt(5)
  buffer_load_dwordx4 v[120:123], v2, s[40:43], s48 offen offset:2048 nt
  buffer_load_dwordx4 v[124:127], v2, s[40:43], s48 offen offset:3072 nt
  v_mfma_f32_16x16x32_bf16 v[12:15], v[96:99], v[64:67], v[12:15]
  v_and_b32_dpp v68, v57, v8 row_newbcast:0 row_mask:0xf bank_mask:0xf
  v_and_b32_dpp v69, v57, v9 row_newbcast:0 row_mask:0xf bank_mask:0xf
  v_and_b32_dpp v70, v57, v10 row_newbcast:0 row_mask:0xf bank_mask:0xf
  v_and_b32_dpp v71, v57, v11 row_newbcast:0 row_mask:0xf bank_mask:0xf
  s_waitcnt vmcnt(6)
  s_mov_b32 s48, 425984
  buffer_load_dwordx4 v[128:131], v2, s[40:43], s48 offen offset:0 nt
  buffer_load_dwordx4 v[132:135], v2, s[40:43], s48 offen offset:1024 nt
  v_mfma_f32_16x16x32_bf16 v[12:15], v[100:103], v[68:71], v[12:15]
  v_and_b32_dpp v64, v58, v8 row_newbcast:0 row_mask:0xf bank_mask:0xf
  v_and_b32_dpp v65, v58, v9 row_newbcast:0 row_mask:0xf bank_mask:0xf
  v_and_b32_dpp v66, v58, v10 row_newbcast:0 row_mask:0xf bank_mask:0xf
  v_and_b32_dpp v67, v58, v11 row_newbcast:0 row_mask:0xf bank_mask:0xf
  s_waitcnt vmcnt(7)
  buffer_load_dwordx4 v[136:139], v2, s[40:43], s48 offen offset:2048 nt
  buffer_load_dwordx4 v[140:143], v2, s[40:43], s48 offen offset:3072 nt
  v_mfma_f32_16x16x32_bf16 v[12:15], v[104:107], v[64:67], v[12:15]
  v_and_b32_dpp v68, v59, v8 row_newbcast:0 row_mask:0xf bank_mask:0xf
  v_and_b32_dpp v69, v59, v9 row_newbcast:0 row_mask:0xf bank_mask:0xf
  v_and_b32_dpp v70, v59, v10 row_newbcast:0 row_mask:0xf bank_mask:0xf
  v_and_b32_dpp v71, v59, v11 row_newbcast:0 row_mask:0xf bank_mask:0xf
  s_waitcnt vmcnt(8)
  s_mov_b32 s48, 442368
  buffer_load_dwordx4 v[144:147], v2, s[40:43], s48 offen offset:0 nt
  v_mfma_f32_16x16x32_bf16 v[12:15], v[108:111], v[68:71], v[12:15]
  v_and_b32_dpp v64, v56, v8 row_newbcast:4 row_mask:0xf bank_mask:0xf
  v_and_b32_dpp v65, v56, v9 row_newbcast:4 row_mask:0xf bank_mask:0xf
  v_and_b32_dpp v66, v56, v10 row_newbcast:4 row_mask:0xf bank_mask:0xf
  v_and_b32_dpp v67, v56, v11 row_newbcast:4 row_mask:0xf bank_mask:0xf
  s_waitcnt vmcnt(8)
  buffer_load_dwordx4 v[148:151], v2, s[40:43], s48 offen offset:1024 nt
  v_mfma_f32_16x16x32_bf16 v[12:15], v[112:115], v[64:67], v[12:15]
  v_and_b32_dpp v68, v57, v8 row_newbcast:4 row_mask:0xf bank_mask:0xf
  v_and_b32_dpp v69, v57, v9 row_newbcast:4 row_mask:0xf bank_mask:0xf
  v_and_b32_dpp v70, v57, v10 row_newbcast:4 row_mask:0xf bank_mask:0xf
  v_and_b32_dpp v71, v57, v11 row_newbcast:4 row_mask:0xf bank_mask:0xf
  s_waitcnt vmcnt(8)
  buffer_load_dwordx4 v[152:155], v2, s[40:43], s48 offen offset:2048 nt
  v_mfma_f32_16x16x32_bf16 v[12:15], v[116:119], v[68:71], v[12:15]
  v_and_b32_dpp v64, v58, v8 row_newbcast:4 row_mask:0xf bank_mask:0xf
  v_and_b32_dpp v65, v58, v9 row_newbcast:4 row_mask:0xf bank_mask:0xf
  v_and_b32_dpp v66, v58, v10 row_newbcast:4 row_mask:0xf bank_mask:0xf
  v_and_b32_dpp v67, v58, v11 row_newbcast:4 row_mask:0xf bank_mask:0xf
  s_waitcnt vmcnt(8)
  buffer_load_dwordx4 v[156:159], v2, s[40:43], s48 offen offset:3072 nt
  v_mfma_f32_16x16x32_bf16 v[12:15], v[120:123], v[64:67], v[12:15]
  v_and_b32_dpp v68, v59, v8 row_newbcast:4 row_mask:0xf bank_mask:0xf
  v_and_b32_dpp v69, v59, v9 row_newbcast:4 row_mask:0xf bank_mask:0xf
  v_and_b32_dpp v70, v59, v10 row_newbcast:4 row_mask:0xf bank_mask:0xf
  v_and_b32_dpp v71, v59, v11 row_newbcast:4 row_mask:0xf bank_mask:0xf
  s_waitcnt vmcnt(8)
  s_mov_b32 s48, 458752
  buffer_load_dwordx4 v[160:163], v2, s[40:43], s48 offen offset:0 nt
  v_mfma_f32_16x16x32_bf16 v[12:15], v[124:127], v[68:71], v[12:15]
  v_and_b32_dpp v64, v56, v8 row_newbcast:8 row_mask:0xf bank_mask:0xf
  v_and_b32_dpp v65, v56, v9 row_newbcast:8 row_mask:0xf bank_mask:0xf
  v_and_b32_dpp v66, v56, v10 row_newbcast:8 row_mask:0xf bank_mask:0xf
  v_and_b32_dpp v67, v56, v11 row_newbcast:8 row_mask:0xf bank_mask:0xf
  s_waitcnt vmcnt(8)
  buffer_load_dwordx4 v[164:167], v2, s[40:43], s48 offen offset:1024 nt
  v_mfma_f32_16x16x32_bf16 v[12:15], v[128:131], v[64:67], v[12:15]
  v_and_b32_dpp v68, v57, v8 row_newbcast:8 row_mask:0xf bank_mask:0xf
  v_and_b32_dpp v69, v57, v9 row_newbcast:8 row_mask:0xf bank_mask:0xf
  v_and_b32_dpp v70, v57, v10 row_newbcast:8 row_mask:0xf bank_mask:0xf
  v_and_b32_dpp v71, v57, v11 row_newbcast:8 row_mask:0xf bank_mask:0xf
  s_waitcnt vmcnt(8)
  buffer_load_dwordx4 v[168:171], v2, s[40:43], s48 offen offset:2048 nt
  v_mfma_f32_16x16x32_bf16 v[12:15], v[132:135], v[68:71], v[12:15]
  v_and_b32_dpp v64, v58, v8 row_newbcast:8 row_mask:0xf bank_mask:0xf
  v_and_b32_dpp v65, v58, v9 row_newbcast:8 row_mask:0xf bank_mask:0xf
  v_and_b32_dpp v66, v58, v10 row_newbcast:8 row_mask:0xf bank_mask:0xf
  v_and_b32_dpp v67, v58, v11 row_newbcast:8 row_mask:0xf bank_mask:0xf
  s_waitcnt vmcnt(8)
  buffer_load_dwordx4 v[172:175], v2, s[40:43], s48 offen offset:3072 nt
  v_mfma_f32_16x16x32_bf16 v[12:15], v[136:139], v[64:67], v[12:15]
  v_and_b32_dpp v68, v59, v8 row_newbcast:8 row_mask:0xf bank_mask:0xf
  v_and_b32_dpp v69, v59, v9 row_newbcast:8 row_mask:0xf bank_mask:0xf
  v_and_b32_dpp v70, v59, v10 row_newbcast:8 row_mask:0xf bank_mask:0xf
  v_and_b32_dpp v71, v59, v11 row_newbcast:8 row_mask:0xf bank_mask:0xf
  s_waitcnt vmcnt(8)
  s_mov_b32 s48, 475136
  buffer_load_dwordx4 v[176:179], v2, s[40:43], s48 offen offset:0 nt
  v_mfma_f32_16x16x32_bf16 v[12:15], v[140:143], v[68:71], v[12:15]
  v_and_b32_dpp v64, v56, v8 row_newbcast:12 row_mask:0xf bank_mask:0xf
  v_and_b32_dpp v65, v56, v9 row_newbcast:12 row_mask:0xf bank_mask:0xf
  v_and_b32_dpp v66, v56, v10 row_newbcast:12 row_mask:0xf bank_mask:0xf
  v_and_b32_dpp v67, v56, v11 row_newbcast:12 row_mask:0xf bank_mask:0xf
  s_waitcnt vmcnt(8)
  buffer_load_dwordx4 v[180:183], v2, s[40:43], s48 offen offset:1024 nt
  v_mfma_f32_16x16x32_bf16 v[12:15], v[144:147], v[64:67], v[12:15]
  v_and_b32_dpp v68, v57, v8 row_newbcast:12 row_mask:0xf bank_mask:0xf
  v_and_b32_dpp v69, v57, v9 row_newbcast:12 row_mask:0xf bank_mask:0xf
  v_and_b32_dpp v70, v57, v10 row_newbcast:12 row_mask:0xf bank_mask:0xf
  v_and_b32_dpp v71, v57, v11 row_newbcast:12 row_mask:0xf bank_mask:0xf
  s_waitcnt vmcnt(8)
  buffer_load_dwordx4 v[184:187], v2, s[40:43], s48 offen offset:2048 nt
  v_mfma_f32_16x16x32_bf16 v[12:15], v[148:151], v[68:71], v[12:15]
  v_and_b32_dpp v64, v58, v8 row_newbcast:12 row_mask:0xf bank_mask:0xf
  v_and_b32_dpp v65, v58, v9 row_newbcast:12 row_mask:0xf bank_mask:0xf
  v_and_b32_dpp v66, v58, v10 row_newbcast:12 row_mask:0xf bank_mask:0xf
  v_and_b32_dpp v67, v58, v11 row_newbcast:12 row_mask:0xf bank_mask:0xf
  s_waitcnt vmcnt(8)
  buffer_load_dwordx4 v[188:191], v2, s[40:43], s48 offen offset:3072 nt
  v_mfma_f32_16x16x32_bf16 v[12:15], v[152:155], v[64:67], v[12:15]
  v_and_b32_dpp v68, v59, v8 row_newbcast:12 row_mask:0xf bank_mask:0xf
  v_and_b32_dpp v69, v59, v9 row_newbcast:12 row_mask:0xf bank_mask:0xf
  v_and_b32_dpp v70, v59, v10 row_newbcast:12 row_mask:0xf bank_mask:0xf
  v_and_b32_dpp v71, v59, v11 row_newbcast:12 row_mask:0xf bank_mask:0xf
  s_waitcnt vmcnt(8)
  s_mov_b32 s48, 491520
  buffer_load_dwordx4 v[192:195], v2, s[40:43], s48 offen offset:0 nt
  v_mfma_f32_16x16x32_bf16 v[12:15], v[156:159], v[68:71], v[12:15]
  v_and_b32_dpp v64, v60, v8 row_newbcast:0 row_mask:0xf bank_mask:0xf
  v_and_b32_dpp v65, v60, v9 row_newbcast:0 row_mask:0xf bank_mask:0xf
  v_and_b32_dpp v66, v60, v10 row_newbcast:0 row_mask:0xf bank_mask:0xf
  v_and_b32_dpp v67, v60, v11 row_newbcast:0 row_mask:0xf bank_mask:0xf
  s_waitcnt vmcnt(8)
  buffer_load_dwordx4 v[196:199], v2, s[40:43], s48 offen offset:1024 nt
  v_mfma_f32_16x16x32_bf16 v[12:15], v[160:163], v[64:67], v[12:15]
  v_and_b32_dpp v68, v61, v8 row_newbcast:0 row_mask:0xf bank_mask:0xf
  v_and_b32_dpp v69, v61, v9 row_newbcast:0 row_mask:0xf bank_mask:0xf
  v_and_b32_dpp v70, v61, v10 row_newbcast:0 row_mask:0xf bank_mask:0xf
  v_and_b32_dpp v71, v61, v11 row_newbcast:0 row_mask:0xf bank_mask:0xf
  s_waitcnt vmcnt(8)
  buffer_load_dwordx4 v[200:203], v2, s[40:43], s48 offen offset:2048 nt
  v_mfma_f32_16x16x32_bf16 v[12:15], v[164:167], v[68:71], v[12:15]
  v_and_b32_dpp v64, v62, v8 row_newbcast:0 row_mask:0xf bank_mask:0xf
  v_and_b32_dpp v65, v62, v9 row_newbcast:0 row_mask:0xf bank_mask:0xf
  v_and_b32_dpp v66, v62, v10 row_newbcast:0 row_mask:0xf bank_mask:0xf
  v_and_b32_dpp v67, v62, v11 row_newbcast:0 row_mask:0xf bank_mask:0xf
  s_waitcnt vmcnt(8)
  buffer_load_dwordx4 v[204:207], v2, s[40:43], s48 offen offset:3072 nt
  v_mfma_f32_16x16x32_bf16 v[12:15], v[168:171], v[64:67], v[12:15]
  v_and_b32_dpp v68, v63, v8 row_newbcast:0 row_mask:0xf bank_mask:0xf
  v_and_b32_dpp v69, v63, v9 row_newbcast:0 row_mask:0xf bank_mask:0xf
  v_and_b32_dpp v70, v63, v10 row_newbcast:0 row_mask:0xf bank_mask:0xf
  v_and_b32_dpp v71, v63, v11 row_newbcast:0 row_mask:0xf bank_mask:0xf
  s_waitcnt vmcnt(8)
  s_mov_b32 s48, 507904
  buffer_load_dwordx4 v[208:211], v2, s[40:43], s48 offen offset:0 nt
  v_mfma_f32_16x16x32_bf16 v[12:15], v[172:175], v[68:71], v[12:15]
  v_and_b32_dpp v64, v60, v8 row_newbcast:4 row_mask:0xf bank_mask:0xf
  v_and_b32_dpp v65, v60, v9 row_newbcast:4 row_mask:0xf bank_mask:0xf
  v_and_b32_dpp v66, v60, v10 row_newbcast:4 row_mask:0xf bank_mask:0xf
  v_and_b32_dpp v67, v60, v11 row_newbcast:4 row_mask:0xf bank_mask:0xf
  s_waitcnt vmcnt(8)
  buffer_load_dwordx4 v[212:215], v2, s[40:43], s48 offen offset:1024 nt
  v_mfma_f32_16x16x32_bf16 v[12:15], v[176:179], v[64:67], v[12:15]
  v_and_b32_dpp v68, v61, v8 row_newbcast:4 row_mask:0xf bank_mask:0xf
  v_and_b32_dpp v69, v61, v9 row_newbcast:4 row_mask:0xf bank_mask:0xf
  v_and_b32_dpp v70, v61, v10 row_newbcast:4 row_mask:0xf bank_mask:0xf
  v_and_b32_dpp v71, v61, v11 row_newbcast:4 row_mask:0xf bank_mask:0xf
  v_mov_b32 v76, 14224
  v_mov_b32 v77, 4
  s_mov_b64 exec, 1
  ds_max_u32 v76, v77
  s_mov_b64 exec, -1
  s_waitcnt vmcnt(8)
  buffer_load_dwordx4 v[216:219], v2, s[40:43], s48 offen offset:2048 nt
  v_mfma_f32_16x16x32_bf16 v[12:15], v[180:183], v[68:71], v[12:15]
  v_and_b32_dpp v64, v62, v8 row_newbcast:4 row_mask:0xf bank_mask:0xf
  v_and_b32_dpp v65, v62, v9 row_newbcast:4 row_mask:0xf bank_mask:0xf
  v_and_b32_dpp v66, v62, v10 row_newbcast:4 row_mask:0xf bank_mask:0xf
  v_and_b32_dpp v67, v62, v11 row_newbcast:4 row_mask:0xf bank_mask:0xf
  s_waitcnt vmcnt(8)
  buffer_load_dwordx4 v[220:223], v2, s[40:43], s48 offen offset:3072 nt
  v_mfma_f32_16x16x32_bf16 v[12:15], v[184:187], v[64:67], v[12:15]
  v_and_b32_dpp v68, v63, v8 row_newbcast:4 row_mask:0xf bank_mask:0xf
  v_and_b32_dpp v69, v63, v9 row_newbcast:4 row_mask:0xf bank_mask:0xf
  v_and_b32_dpp v70, v63, v10 row_newbcast:4 row_mask:0xf bank_mask:0xf
  v_and_b32_dpp v71, v63, v11 row_newbcast:4 row_mask:0xf bank_mask:0xf
  s_waitcnt vmcnt(8)
  s_nop 0
  v_mfma_f32_16x16x32_bf16 v[12:15], v[188:191], v[68:71], v[12:15]
  v_and_b32_dpp v64, v60, v8 row_newbcast:8 row_mask:0xf bank_mask:0xf
  v_and_b32_dpp v65, v60, v9 row_newbcast:8 row_mask:0xf bank_mask:0xf
  v_and_b32_dpp v66, v60, v10 row_newbcast:8 row_mask:0xf bank_mask:0xf
  v_and_b32_dpp v67, v60, v11 row_newbcast:8 row_mask:0xf bank_mask:0xf
  s_waitcnt vmcnt(7)
  s_nop 0
  v_mfma_f32_16x16x32_bf16 v[12:15], v[192:195], v[64:67], v[12:15]
  v_and_b32_dpp v68, v61, v8 row_newbcast:8 row_mask:0xf bank_mask:0xf
  v_and_b32_dpp v69, v61, v9 row_newbcast:8 row_mask:0xf bank_mask:0xf
  v_and_b32_dpp v70, v61, v10 row_newbcast:8 row_mask:0xf bank_mask:0xf
  v_and_b32_dpp v71, v61, v11 row_newbcast:8 row_mask:0xf bank_mask:0xf
  s_waitcnt vmcnt(6)
  s_nop 0
  v_mfma_f32_16x16x32_bf16 v[12:15], v[196:199], v[68:71], v[12:15]
  v_and_b32_dpp v64, v62, v8 row_newbcast:8 row_mask:0xf bank_mask:0xf
  v_and_b32_dpp v65, v62, v9 row_newbcast:8 row_mask:0xf bank_mask:0xf
  v_and_b32_dpp v66, v62, v10 row_newbcast:8 row_mask:0xf bank_mask:0xf
  v_and_b32_dpp v67, v62, v11 row_newbcast:8 row_mask:0xf bank_mask:0xf
  s_waitcnt vmcnt(5)
  s_nop 0
  v_mfma_f32_16x16x32_bf16 v[12:15], v[200:203], v[64:67], v[12:15]
  v_and_b32_dpp v68, v63, v8 row_newbcast:8 row_mask:0xf bank_mask:0xf
  v_and_b32_dpp v69, v63, v9 row_newbcast:8 row_mask:0xf bank_mask:0xf
  v_and_b32_dpp v70, v63, v10 row_newbcast:8 row_mask:0xf bank_mask:0xf
  v_and_b32_dpp v71, v63, v11 row_newbcast:8 row_mask:0xf bank_mask:0xf
  s_waitcnt vmcnt(4)
  s_nop 0
  v_mfma_f32_16x16x32_bf16 v[12:15], v[204:207], v[68:71], v[12:15]
  v_and_b32_dpp v64, v60, v8 row_newbcast:12 row_mask:0xf bank_mask:0xf
  v_and_b32_dpp v65, v60, v9 row_newbcast:12 row_mask:0xf bank_mask:0xf
  v_and_b32_dpp v66, v60, v10 row_newbcast:12 row_mask:0xf bank_mask:0xf
  v_and_b32_dpp v67, v60, v11 row_newbcast:12 row_mask:0xf bank_mask:0xf
  s_waitcnt vmcnt(3)
  s_nop 0
  v_mfma_f32_16x16x32_bf16 v[12:15], v[208:211], v[64:67], v[12:15]
  v_and_b32_dpp v68, v61, v8 row_newbcast:12 row_mask:0xf bank_mask:0xf
  v_and_b32_dpp v69, v61, v9 row_newbcast:12 row_mask:0xf bank_mask:0xf
  v_and_b32_dpp v70, v61, v10 row_newbcast:12 row_mask:0xf bank_mask:0xf
  v_and_b32_dpp v71, v61, v11 row_newbcast:12 row_mask:0xf bank_mask:0xf
  s_waitcnt vmcnt(2)
  s_nop 0
  v_mfma_f32_16x16x32_bf16 v[12:15], v[212:215], v[68:71], v[12:15]
  v_and_b32_dpp v64, v62, v8 row_newbcast:12 row_mask:0xf bank_mask:0xf
  v_and_b32_dpp v65, v62, v9 row_newbcast:12 row_mask:0xf bank_mask:0xf
  v_and_b32_dpp v66, v62, v10 row_newbcast:12 row_mask:0xf bank_mask:0xf
  v_and_b32_dpp v67, v62, v11 row_newbcast:12 row_mask:0xf bank_mask:0xf
  s_waitcnt vmcnt(1)
  s_nop 0
  v_mfma_f32_16x16x32_bf16 v[12:15], v[216:219], v[64:67], v[12:15]
  v_and_b32_dpp v68, v63, v8 row_newbcast:12 row_mask:0xf bank_mask:0xf
  v_and_b32_dpp v69, v63, v9 row_newbcast:12 row_mask:0xf bank_mask:0xf
  v_and_b32_dpp v70, v63, v10 row_newbcast:12 row_mask:0xf bank_mask:0xf
  v_and_b32_dpp v71, v63, v11 row_newbcast:12 row_mask:0xf bank_mask:0xf
  s_waitcnt vmcnt(0)
  s_nop 0
  v_mfma_f32_16x16x32_bf16 v[12:15], v[220:223], v[68:71], v[12:15]
  s_nop 7
  v_mul_f32 v12, v75, v12
  v_mul_f32 v13, v75, v13
  v_mul_f32 v14, v75, v14
  v_mul_f32 v15, v75, v15
  s_mov_b32 exec_lo, 0xff00ff
  s_mov_b32 exec_hi, 0xff00ff
  ds_write_b128 v72, v[12:15]
  s_mov_b64 exec, -1
  s_waitcnt lgkmcnt(0)
  s_barrier
  s_endpgm
L_service:
  v_and_b32 v2, 15, v1
  v_lshrrev_b32 v3, 4, v1
  v_mov_b32 v82, 0
  v_mov_b32 v84, 0
  v_mov_b32 v85, 0
  v_mov_b32 v93, 0
  v_mov_b32 v94, 0
  v_mov_b32 v95, 0
  v_mul_u32_u24 v8, 20, v1
  s_mul_i32 s49, s33, 1280
  v_add_u32 v8, s49, v8
  v_lshlrev_b32 v9, 13, v3
  v_lshl_add_u32 v9, v2, 4, v9
  s_mul_i32 s50, s32, 80
  s_mul_i32 s51, s33, 20
  s_add_u32 s50, s50, s51
  s_lshl_b32 s48, s50, 13
  s_lshl_b32 s51, s29, 8
  s_waitcnt lgkmcnt(0)
  s_setprio 3
  global_load_dwordx4 v[24:27], v8, s[4:5]
  global_load_dword v28, v8, s[4:5] offset:16
  s_add_u32 s36, s10, s51
  s_addc_u32 s37, s11, 0
  s_mov_b32 s38, 5242880
  s_mov_b32 s39, 0x20000
  buffer_load_dwordx4 v[96:99], v9, s[36:39], s48 offen nt
  s_add_u32 s48, s48, 32768
  buffer_load_dwordx4 v[100:103], v9, s[36:39], s48 offen nt
  s_add_u32 s48, s48, 32768
  buffer_load_dwordx4 v[104:107], v9, s[36:39], s48 offen nt
  s_add_u32 s48, s48, 32768
  buffer_load_dwordx4 v[108:111], v9, s[36:39], s48 offen nt
  s_add_u32 s48, s48, 32768
  buffer_load_dwordx4 v[112:115], v9, s[36:39], s48 offen nt
  v_mov_b32 v4, 14208
  v_mov_b32 v5, 1
  v_mov_b32 v16, 0
  v_mov_b32 v17, 0
  v_mov_b32 v18, 0
  v_mov_b32 v19, 0
  v_mov_b32 v20, -1
  v_lshlrev_b32 v21, 2, v1
  v_add_u32 v22, 14144, v21
  v_add_u32 v21, 14208, v21
  s_mov_b32 exec_lo, 0xff
  s_mov_b32 exec_hi, 0x0
  ds_write_b32 v22, v20
  ds_write_b32 v21, v16
  s_mov_b64 exec, -1
  s_waitcnt lgkmcnt(0)
  s_barrier
  s_mov_b32 s52, 4194304
  s_load_dword s55, s[26:27], s52
  v_bfe_u32 v20, v2, 1, 2
  v_and_b32 v21, 1, v2
  v_mov_b32 v22, 0x0c0c0100
  v_mov_b32 v23, 0x01000c0c
  v_cmp_eq_u32 vcc, 1, v21
  s_nop 1
  v_cndmask_b32 v22, v22, v23, vcc
  v_mov_b32 v23, 0x0c0c0c0c
  v_cmp_eq_u32 vcc, 0, v20
  s_nop 1
  v_cndmask_b32 v34, v23, v22, vcc
  v_cmp_eq_u32 vcc, 1, v20
  s_nop 1
  v_cndmask_b32 v35, v23, v22, vcc
  v_cmp_eq_u32 vcc, 2, v20
  s_nop 1
  v_cndmask_b32 v36, v23, v22, vcc
  v_cmp_eq_u32 vcc, 3, v20
  s_nop 1
  v_cndmask_b32 v37, v23, v22, vcc
  s_setprio 0
  s_waitcnt lgkmcnt(0)
  s_add_u32 s55, s55, 1
  v_mov_b32 v6, s55
  s_waitcnt vmcnt(5)
  v_lshlrev_b32 v8, 16, v24
  v_and_b32 v9, 0xffff0000, v24
  v_lshlrev_b32 v10, 16, v25
  v_and_b32 v11, 0xffff0000, v25
  v_lshlrev_b32 v12, 16, v26
  v_and_b32 v13, 0xffff0000, v26
  v_lshlrev_b32 v14, 16, v27
  v_and_b32 v15, 0xffff0000, v27
  v_lshlrev_b32 v16, 16, v28
  v_and_b32 v17, 0xffff0000, v28
  v_add_f32 v18, v8, v9
  v_add_f32 v18, v18, v10
  v_add_f32 v18, v18, v11
  v_add_f32 v18, v18, v12
  v_add_f32 v18, v18, v13
  v_add_f32 v18, v18, v14
  v_add_f32 v18, v18, v15
  v_add_f32 v18, v18, v16
  v_add_f32 v18, v18, v17
  s_nop 1
  v_add_f32_dpp v18, v18, v18 row_ror:8 row_mask:0xf bank_mask:0xf
  s_nop 1
  v_add_f32_dpp v18, v18, v18 row_ror:4 row_mask:0xf bank_mask:0xf
  s_nop 1
  v_add_f32_dpp v18, v18, v18 row_ror:2 row_mask:0xf bank_mask:0xf
  s_nop 1
  v_add_f32_dpp v18, v18, v18 row_ror:1 row_mask:0xf bank_mask:0xf
  v_mov_b32 v19, v18
  s_nop 1
  v_permlane16_swap_b32 v19, v18
  v_add_f32 v18, v18, v19
  v_mov_b32 v19, v18
  s_nop 1
  v_permlane32_swap_b32 v19, v18
  v_add_f32 v18, v18, v19
  v_mul_f32 v18, 0x3acccccd, v18
  v_sub_f32 v19, v8, v18
  v_mul_f32 v21, v19, v19
  v_sub_f32 v19, v9, v18
  v_fmac_f32 v21, v19, v19
  v_sub_f32 v19, v10, v18
  v_fmac_f32 v21, v19, v19
  v_sub_f32 v19, v11, v18
  v_fmac_f32 v21, v19, v19
  v_sub_f32 v19, v12, v18
  v_fmac_f32 v21, v19, v19
  v_sub_f32 v19, v13, v18
  v_fmac_f32 v21, v19, v19
  v_sub_f32 v19, v14, v18
  v_fmac_f32 v21, v19, v19
  v_sub_f32 v19, v15, v18
  v_fmac_f32 v21, v19, v19
  v_sub_f32 v19, v16, v18
  v_fmac_f32 v21, v19, v19
  v_sub_f32 v19, v17, v18
  v_fmac_f32 v21, v19, v19
  s_nop 1
  v_add_f32_dpp v21, v21, v21 row_ror:8 row_mask:0xf bank_mask:0xf
  s_nop 1
  v_add_f32_dpp v21, v21, v21 row_ror:4 row_mask:0xf bank_mask:0xf
  s_nop 1
  v_add_f32_dpp v21, v21, v21 row_ror:2 row_mask:0xf bank_mask:0xf
  s_nop 1
  v_add_f32_dpp v21, v21, v21 row_ror:1 row_mask:0xf bank_mask:0xf
  v_mov_b32 v19, v21
  s_nop 1
  v_permlane16_swap_b32 v19, v21
  v_add_f32 v21, v21, v19
  v_mov_b32 v19, v21
  s_nop 1
  v_permlane32_swap_b32 v19, v21
  v_add_f32 v21, v21, v19
  v_mul_f32 v21, 0x3acccccd, v21
  v_cvt_pk_bf16_f32 v18, v18, v18
  v_and_b32 v18, 0xffff0000, v18
  v_cvt_pk_bf16_f32 v21, v21, v21
  v_and_b32 v21, 0xffff0000, v21
  v_add_f32 v21, 0x3727c5ac, v21
  v_cvt_pk_bf16_f32 v21, v21, v21
  v_and_b32 v21, 0xffff0000, v21
  v_sqrt_f32 v21, v21
  s_nop 0
  v_cvt_pk_bf16_f32 v21, v21, v21
  v_and_b32 v21, 0xffff0000, v21
  v_rcp_f32 v21, v21
  v_sub_f32 v8, v8, v18
  v_sub_f32 v9, v9, v18
  v_cvt_pk_bf16_f32 v19, v8, v9
  v_lshlrev_b32 v8, 16, v19
  v_and_b32 v9, 0xffff0000, v19
  v_mul_f32 v8, v8, v21
  v_mul_f32 v9, v9, v21
  v_cvt_pk_bf16_f32 v24, v8, v9
  v_sub_f32 v10, v10, v18
  v_sub_f32 v11, v11, v18
  v_cvt_pk_bf16_f32 v19, v10, v11
  v_lshlrev_b32 v10, 16, v19
  v_and_b32 v11, 0xffff0000, v19
  v_mul_f32 v10, v10, v21
  v_mul_f32 v11, v11, v21
  v_cvt_pk_bf16_f32 v25, v10, v11
  v_sub_f32 v12, v12, v18
  v_sub_f32 v13, v13, v18
  v_cvt_pk_bf16_f32 v19, v12, v13
  v_lshlrev_b32 v12, 16, v19
  v_and_b32 v13, 0xffff0000, v19
  v_mul_f32 v12, v12, v21
  v_mul_f32 v13, v13, v21
  v_cvt_pk_bf16_f32 v26, v12, v13
  v_sub_f32 v14, v14, v18
  v_sub_f32 v15, v15, v18
  v_cvt_pk_bf16_f32 v19, v14, v15
  v_lshlrev_b32 v14, 16, v19
  v_and_b32 v15, 0xffff0000, v19
  v_mul_f32 v14, v14, v21
  v_mul_f32 v15, v15, v21
  v_cvt_pk_bf16_f32 v27, v14, v15
  v_sub_f32 v16, v16, v18
  v_sub_f32 v17, v17, v18
  v_cvt_pk_bf16_f32 v19, v16, v17
  v_lshlrev_b32 v16, 16, v19
  v_and_b32 v17, 0xffff0000, v19
  v_mul_f32 v16, v16, v21
  v_mul_f32 v17, v17, v21
  v_cvt_pk_bf16_f32 v28, v16, v17
  v_mul_u32_u24 v19, 20, v1
  s_mul_i32 s49, s33, 1280
  s_add_u32 s49, s49, 0
  v_add_u32 v19, s49, v19
  ds_write_b32 v19, v24 offset:0
  ds_write_b32 v19, v25 offset:4
  ds_write_b32 v19, v26 offset:8
  ds_write_b32 v19, v27 offset:12
  ds_write_b32 v19, v28 offset:16
  s_mov_b64 exec, 1
  ds_add_u32 v4, v5 offset:0
  s_mov_b64 exec, -1
  s_mov_b32 s53, 400000
L_sync_2:
  ds_read_b32 v8, v4 offset:0
  s_sub_u32 s53, s53, 1
  s_cbranch_scc1 L_sync_2_x
  s_waitcnt lgkmcnt(0)
  v_readfirstlane_b32 s49, v8
  s_nop 0
  s_cmp_ge_u32 s49, 4
  s_cbranch_scc0 L_sync_2
L_sync_2_x:
  s_waitcnt lgkmcnt(0)
  v_lshrrev_b32 v8, 3, v2
  v_mul_u32_u24 v8, 1280, v8
  v_lshl_add_u32 v8, v3, 1, v8
  s_lshl_b32 s49, s50, 1
  s_add_u32 s49, s49, 0
  v_add_u32 v8, s49, v8
  ds_read_u16 v38, v8 offset:0
  ds_read_u16 v39, v8 offset:2560
  ds_read_u16 v40, v8 offset:8
  ds_read_u16 v41, v8 offset:2568
  ds_read_u16 v42, v8 offset:16
  ds_read_u16 v43, v8 offset:2576
  ds_read_u16 v44, v8 offset:24
  ds_read_u16 v45, v8 offset:2584
  ds_read_u16 v46, v8 offset:32
  ds_read_u16 v47, v8 offset:2592
  v_mov_b32 v48, 0
  v_mov_b32 v49, 0
  v_mov_b32 v50, 0
  v_mov_b32 v51, 0
  v_mov_b32 v52, 0
  v_mov_b32 v53, 0
  v_mov_b32 v54, 0
  v_mov_b32 v55, 0
  s_waitcnt lgkmcnt(0)
  v_perm_b32 v56, v38, v38, v34
  v_perm_b32 v57, v38, v38, v35
  v_perm_b32 v58, v38, v38, v36
  v_perm_b32 v59, v38, v38, v37
  v_perm_b32 v60, v39, v39, v34
  v_perm_b32 v61, v39, v39, v35
  v_perm_b32 v62, v39, v39, v36
  v_perm_b32 v63, v39, v39, v37
  s_waitcnt vmcnt(4)
  v_mfma_f32_16x16x32_bf16 v[48:51], v[96:99], v[56:59], v[48:51]
  v_mfma_f32_16x16x32_bf16 v[52:55], v[96:99], v[60:63], v[52:55]
  v_perm_b32 v56, v40, v40, v34
  v_perm_b32 v57, v40, v40, v35
  v_perm_b32 v58, v40, v40, v36
  v_perm_b32 v59, v40, v40, v37
  v_perm_b32 v60, v41, v41, v34
  v_perm_b32 v61, v41, v41, v35
  v_perm_b32 v62, v41, v41, v36
  v_perm_b32 v63, v41, v41, v37
  s_waitcnt vmcnt(3)
  v_mfma_f32_16x16x32_bf16 v[48:51], v[100:103], v[56:59], v[48:51]
  v_mfma_f32_16x16x32_bf16 v[52:55], v[100:103], v[60:63], v[52:55]
  v_perm_b32 v56, v42, v42, v34
  v_perm_b32 v57, v42, v42, v35
  v_perm_b32 v58, v42, v42, v36
  v_perm_b32 v59, v42, v42, v37
  v_perm_b32 v60, v43, v43, v34
  v_perm_b32 v61, v43, v43, v35
  v_perm_b32 v62, v43, v43, v36
  v_perm_b32 v63, v43, v43, v37
  s_waitcnt vmcnt(2)
  v_mfma_f32_16x16x32_bf16 v[48:51], v[104:107], v[56:59], v[48:51]
  v_mfma_f32_16x16x32_bf16 v[52:55], v[104:107], v[60:63], v[52:55]
  v_perm_b32 v56, v44, v44, v34
  v_perm_b32 v57, v44, v44, v35
  v_perm_b32 v58, v44, v44, v36
  v_perm_b32 v59, v44, v44, v37
  v_perm_b32 v60, v45, v45, v34
  v_perm_b32 v61, v45, v45, v35
  v_perm_b32 v62, v45, v45, v36
  v_perm_b32 v63, v45, v45, v37
  s_waitcnt vmcnt(1)
  v_mfma_f32_16x16x32_bf16 v[48:51], v[108:111], v[56:59], v[48:51]
  v_mfma_f32_16x16x32_bf16 v[52:55], v[108:111], v[60:63], v[52:55]
  v_perm_b32 v56, v46, v46, v34
  v_perm_b32 v57, v46, v46, v35
  v_perm_b32 v58, v46, v46, v36
  v_perm_b32 v59, v46, v46, v37
  v_perm_b32 v60, v47, v47, v34
  v_perm_b32 v61, v47, v47, v35
  v_perm_b32 v62, v47, v47, v36
  v_perm_b32 v63, v47, v47, v37
  s_waitcnt vmcnt(0)
  v_mfma_f32_16x16x32_bf16 v[48:51], v[112:115], v[56:59], v[48:51]
  v_mfma_f32_16x16x32_bf16 v[52:55], v[112:115], v[60:63], v[52:55]
  v_lshrrev_b32 v8, 3, v2
  v_lshlrev_b32 v8, 9, v8
  v_lshl_add_u32 v8, v3, 7, v8
  v_and_b32 v9, 7, v2
  v_lshl_add_u32 v8, v9, 2, v8
  s_lshl_b32 s49, s33, 11
  s_add_u32 s49, s49, 5120
  v_add_u32 v8, s49, v8
  ds_write_b32 v8, v48 offset:0
  ds_write_b32 v8, v49 offset:32
  ds_write_b32 v8, v50 offset:64
  ds_write_b32 v8, v51 offset:96
  ds_write_b32 v8, v52 offset:1024
  ds_write_b32 v8, v53 offset:1056
  ds_write_b32 v8, v54 offset:1088
  ds_write_b32 v8, v55 offset:1120
  s_mov_b64 exec, 1
  ds_add_u32 v4, v5 offset:4
  s_mov_b64 exec, -1
  s_mov_b32 s53, 400000
L_sync_3:
  ds_read_b32 v9, v4 offset:4
  s_sub_u32 s53, s53, 1
  s_cbranch_scc1 L_sync_3_x
  s_waitcnt lgkmcnt(0)
  v_readfirstlane_b32 s49, v9
  s_nop 0
  s_cmp_ge_u32 s49, 4
  s_cbranch_scc0 L_sync_3
L_sync_3_x:
  s_waitcnt lgkmcnt(0)
  s_mov_b32 s3, 0xff
  v_and_b32 v9, 31, v1
  v_lshlrev_b32 v9, 4, v9
  s_lshl_b32 s49, s33, 9
  s_add_u32 s49, s49, 5120
  v_add_u32 v8, s49, v9
  ds_read_b128 v[128:131], v8 offset:0
  ds_read_b128 v[132:135], v8 offset:2048
  ds_read_b128 v[136:139], v8 offset:4096
  ds_read_b128 v[140:143], v8 offset:6144
  s_lshl_b32 s49, s29, 2
  s_add_u32 s49, s49, s33
  s_lshl_b32 s49, s49, 3
  s_add_u32 s49, s49, s32
  s_lshl_b32 s49, s49, 9
  s_add_u32 s49, s49, 2621440
  v_add_u32 v20, s49, v9
  s_waitcnt lgkmcnt(0)
  v_add_f32 v128, v128, v132
  v_add_f32 v136, v136, v140
  v_add_f32 v129, v129, v133
  v_add_f32 v137, v137, v141
  v_add_f32 v130, v130, v134
  v_add_f32 v138, v138, v142
  v_add_f32 v131, v131, v135
  v_add_f32 v139, v139, v143
  v_add_f32 v128, v128, v136
  v_add_f32 v129, v129, v137
  v_add_f32 v130, v130, v138
  v_add_f32 v131, v131, v139
  v_add_u32 v128, 0x80, v128
  v_bfi_b32 v128, s3, v6, v128
  v_add_u32 v129, 0x80, v129
  v_bfi_b32 v129, s3, v6, v129
  v_add_u32 v130, 0x80, v130
  v_bfi_b32 v130, s3, v6, v130
  v_add_u32 v131, 0x80, v131
  v_bfi_b32 v131, s3, v6, v131
  s_mov_b32 exec_lo, 0xffffffff
  s_mov_b32 exec_hi, 0x0
  global_store_dwordx4 v20, v[128:131], s[26:27] sc1
  s_mov_b64 exec, -1
  s_cmp_lg_u32 s33, 0
  s_cbranch_scc1 L_noadd_4
  s_lshl_b32 s49, s2, 2
  s_add_u32 s49, s49, 3932160
  v_mov_b32 v9, s49
  s_mov_b64 exec, 1
  global_store_dword v9, v6, s[26:27] sc1
  s_getreg_b32 s14, hwreg(HW_REG_XCC_ID)
  s_and_b32 s14, s14, 15
  s_lshl_b32 s49, s14, 28
  s_add_u32 s49, s49, s55
  v_mov_b32 v10, s49
  s_lshl_b32 s49, s29, 3
  s_add_u32 s49, s49, s32
  s_lshl_b32 s49, s49, 2
  s_add_u32 s49, s49, 3997696
  v_mov_b32 v9, s49
  global_store_dword v9, v10, s[26:27] sc1
  s_mov_b64 exec, -1
L_noadd_4:
  s_bfe_u32 s49, s2, 0x20004
  s_bfe_u32 s50, s2, 0x20001
  s_cmp_ge_u32 s32, 5
  s_cbranch_scc1 L_role_5_np
  s_mul_i32 s51, s49, 5
  s_add_u32 s51, s51, s32
  s_mov_b32 s35, 1
  s_bitcmp1_b32 s2, 0
  s_cbranch_scc1 L_role_5_po
  s_mul_i32 s59, s50, 20
  s_add_u32 s59, s59, s51
  s_branch L_role_5_done
L_role_5_po:
  s_mul_i32 s59, s50, 14
  s_add_u32 s59, s59, s51
  s_add_u32 s59, s59, 80
  s_cmp_lt_u32 s51, 14
  s_cselect_b32 s35, 1, 0
  s_cmp_lt_u32 s59, 135
  s_cselect_b32 s35, s35, 0
  s_branch L_role_5_done
L_role_5_np:
  s_mul_i32 s51, s49, 3
  s_add_u32 s51, s51, s32
  s_sub_u32 s51, s51, 5
  s_bitcmp1_b32 s2, 0
  s_cbranch_scc1 L_role_5_no
  s_mul_i32 s59, s50, 12
  s_add_u32 s59, s59, s51
  s_mov_b32 s35, 2
  s_branch L_role_5_done
L_role_5_no:
  s_mul_i32 s59, s50, 10
  s_add_u32 s59, s59, s51
  s_mov_b32 s35, 3
  s_cmp_lt_u32 s51, 10
  s_cbranch_scc1 L_role_5_done
  s_lshl_b32 s59, s50, 1
  s_add_u32 s59, s59, s51
  s_add_u32 s59, s59, 38
  s_cmp_lt_u32 s59, 54
  s_cselect_b32 s35, 2, 0
L_role_5_done:
  v_add_u32 v8, 0, v1
  v_mul_u32_u24 v10, 3277, v8
  v_lshrrev_b32 v10, 16, v10
  v_mul_u32_u24 v11, 20, v10
  v_sub_u32 v8, v8, v11
  v_mul_u32_u24 v10, 1280, v10
  v_lshl_add_u32 v64, v8, 4, v10
  v_add_u32 v8, 64, v1
  v_mul_u32_u24 v10, 3277, v8
  v_lshrrev_b32 v10, 16, v10
  v_mul_u32_u24 v11, 20, v10
  v_sub_u32 v8, v8, v11
  v_mul_u32_u24 v10, 1280, v10
  v_lshl_add_u32 v65, v8, 4, v10
  v_add_u32 v8, 128, v1
  v_mul_u32_u24 v10, 3277, v8
  v_lshrrev_b32 v10, 16, v10
  v_mul_u32_u24 v11, 20, v10
  v_sub_u32 v8, v8, v11
  v_mul_u32_u24 v10, 1280, v10
  v_lshl_add_u32 v66, v8, 4, v10
  v_add_u32 v8, 192, v1
  v_mul_u32_u24 v10, 3277, v8
  v_lshrrev_b32 v10, 16, v10
  v_mul_u32_u24 v11, 20, v10
  v_sub_u32 v8, v8, v11
  v_mul_u32_u24 v10, 1280, v10
  v_lshl_add_u32 v67, v8, 4, v10
  v_add_u32 v8, 256, v1
  v_mul_u32_u24 v10, 3277, v8
  v_lshrrev_b32 v10, 16, v10
  v_mul_u32_u24 v11, 20, v10
  v_sub_u32 v8, v8, v11
  v_mul_u32_u24 v10, 1280, v10
  v_lshl_add_u32 v68, v8, 4, v10
  s_mul_i32 s58, s33, 10240
  s_add_u32 s58, s58, 55808
  v_bfe_u32 v8, v1, 2, 2
  v_lshl_add_u32 v8, v3, 3, v8
  v_and_b32 v10, 3, v1
  v_lshlrev_b32 v10, 3, v10
  v_mul_u32_u24 v11, 320, v8
  v_add3_u32 v69, v11, v10, s58
  v_lshlrev_b32 v11, 7, v8
  v_add3_u32 v83, v11, v10, s58
  s_lshl_b32 s49, s33, 6
  s_add_u32 s49, s49, 23040
  v_bfe_u32 v11, v1, 2, 2
  v_lshlrev_b32 v11, 3, v11
  v_lshl_add_u32 v11, v3, 1, v11
  v_lshlrev_b32 v11, 8, v11
  v_add3_u32 v92, v11, v10, s49
  v_and_b32 v87, 0xff, v6
  s_cmp_lg_u32 s33, 0
  s_cbranch_scc1 L_qdone_6
  s_lshl_b32 s49, s29, 2
  s_add_u32 s49, s49, s31
  s_lshl_b32 s49, s49, 12
  s_add_u32 s49, s49, 2621440
  v_lshlrev_b32 v20, 4, v1
  v_add_u32 v20, s49, v20
  s_sleep 18
  s_mov_b32 s53, 400000
L_qpoll_7:
  global_load_dwordx4 v[128:131], v20, s[26:27] offset:0 sc1
  global_load_dwordx4 v[132:135], v20, s[26:27] offset:1024 sc1
  global_load_dwordx4 v[136:139], v20, s[26:27] offset:2048 sc1
  global_load_dwordx4 v[140:143], v20, s[26:27] offset:3072 sc1
  s_sub_u32 s53, s53, 1
  s_cbranch_scc1 L_qpoll_7_x
  s_waitcnt vmcnt(0)
  v_xor_b32 v128, v128, v87
  v_xor_b32 v129, v129, v87
  v_xor_b32 v130, v130, v87
  v_xor_b32 v131, v131, v87
  v_xor_b32 v132, v132, v87
  v_xor_b32 v133, v133, v87
  v_xor_b32 v134, v134, v87
  v_xor_b32 v135, v135, v87
  v_xor_b32 v136, v136, v87
  v_xor_b32 v137, v137, v87
  v_xor_b32 v138, v138, v87
  v_xor_b32 v139, v139, v87
  v_xor_b32 v140, v140, v87
  v_xor_b32 v141, v141, v87
  v_xor_b32 v142, v142, v87
  v_xor_b32 v143, v143, v87
  v_or_b32 v22, v128, v129
  v_or3_b32 v22, v22, v130, v131
  v_or3_b32 v22, v22, v132, v133
  v_or3_b32 v22, v22, v134, v135
  v_or3_b32 v22, v22, v136, v137
  v_or3_b32 v22, v22, v138, v139
  v_or3_b32 v22, v22, v140, v141
  v_or3_b32 v22, v22, v142, v143
  v_and_b32 v22, 0xff, v22
  v_cmp_ne_u32 vcc, 0, v22
  s_nop 0
  s_cbranch_vccnz L_qpoll_7
L_qpoll_7_x:
  s_waitcnt vmcnt(0)
  v_add_f32 v128, v128, v132
  v_add_f32 v136, v136, v140
  v_add_f32 v129, v129, v133
  v_add_f32 v137, v137, v141
  v_add_f32 v130, v130, v134
  v_add_f32 v138, v138, v142
  v_add_f32 v131, v131, v135
  v_add_f32 v139, v139, v143
  v_add_f32 v128, v128, v136
  v_add_f32 v129, v129, v137
  v_add_f32 v130, v130, v138
  v_add_f32 v131, v131, v139
  v_mov_b32 v132, v128
  v_mov_b32 v133, v129
  v_mov_b32 v134, v130
  v_mov_b32 v135, v131
  v_permlane32_swap_b32 v132, v128
  v_permlane32_swap_b32 v133, v129
  v_permlane32_swap_b32 v134, v130
  v_permlane32_swap_b32 v135, v131
  v_add_f32 v128, v128, v132
  v_add_f32 v129, v129, v133
  v_add_f32 v130, v130, v134
  v_add_f32 v131, v131, v135
  v_cvt_pk_bf16_f32 v132, v128, v129
  v_cvt_pk_bf16_f32 v133, v130, v131
  v_and_b32 v21, 31, v1
  v_lshlrev_b32 v21, 3, v21
  v_add_u32 v21, 13312, v21
  ds_write_b64 v21, v[132:133]
  s_waitcnt lgkmcnt(0)
L_qdone_6:
  s_barrier
  s_cmp_lg_u32 s35, 1
  s_cbranch_scc1 L_roleA_done_8
  s_mul_i32 s92, s59, 52429
  s_lshr_b32 s92, s92, 18
  s_mul_i32 s50, s92, 5
  s_sub_u32 s93, s59, s50
  s_lshl_b32 s49, s93, 7
  s_lshl_b32 s50, s33, 5
  s_add_u32 s52, s49, s50
  s_mul_i32 s49, s52, 3456
  s_lshl_b32 s50, s92, 7
  s_add_u32 s51, s49, s50
  v_lshrrev_b32 v8, 3, v1
  v_mul_u32_u24 v8, 3456, v8
  v_and_b32 v9, 7, v1
  v_lshl_add_u32 v8, v9, 4, v8
  s_mov_b32 s36, s16
  s_mov_b32 s37, s17
  s_mov_b32 s38, 2211840
  s_mov_b32 s39, 0x20000
  s_mov_b32 s40, s18
  s_mov_b32 s41, s19
  s_mov_b32 s42, 2211840
  s_mov_b32 s43, 0x20000
  s_add_u32 m0, s58, 0
  s_add_u32 s48, s51, 0
  buffer_load_dwordx4 v8, s[36:39], s48 offen nt lds
  s_add_u32 m0, s58, 1024
  s_add_u32 s48, s51, 27648
  buffer_load_dwordx4 v8, s[36:39], s48 offen nt lds
  s_waitcnt vmcnt(1)
  s_add_u32 m0, s58, 2048
  s_add_u32 s48, s51, 55296
  buffer_load_dwordx4 v8, s[36:39], s48 offen nt lds
  s_waitcnt vmcnt(1)
  s_add_u32 m0, s58, 3072
  s_add_u32 s48, s51, 82944
  buffer_load_dwordx4 v8, s[36:39], s48 offen nt lds
  s_waitcnt vmcnt(1)
  s_add_u32 m0, s58, 4096
  s_add_u32 s48, s51, 0
  buffer_load_dwordx4 v8, s[40:43], s48 offen nt lds
  s_waitcnt vmcnt(1)
  s_add_u32 m0, s58, 5120
  s_add_u32 s48, s51, 27648
  buffer_load_dwordx4 v8, s[40:43], s48 offen nt lds
  s_waitcnt vmcnt(1)
  s_add_u32 m0, s58, 6144
  s_add_u32 s48, s51, 55296
  buffer_load_dwordx4 v8, s[40:43], s48 offen nt lds
  s_waitcnt vmcnt(1)
  s_add_u32 m0, s58, 7168
  s_add_u32 s48, s51, 82944
  buffer_load_dwordx4 v8, s[40:43], s48 offen nt lds
  v_and_b32 v9, 3, v2
  v_mul_u32_u24 v9, 1280, v9
  v_lshl_add_u32 v9, v3, 4, v9
  s_lshl_b32 s49, s52, 1
  s_add_u32 s49, s49, 0
  v_add_u32 v9, s49, v9
  ds_read_b128 v[88:91], v9
  s_waitcnt vmcnt(0)
  ds_read_b64_tr_b16 v[24:25], v83 offset:0
  ds_read_b64_tr_b16 v[26:27], v83 offset:512
  ds_read_b64_tr_b16 v[28:29], v83 offset:32
  ds_read_b64_tr_b16 v[30:31], v83 offset:544
  ds_read_b64_tr_b16 v[32:33], v83 offset:64
  ds_read_b64_tr_b16 v[34:35], v83 offset:576
  ds_read_b64_tr_b16 v[36:37], v83 offset:96
  ds_read_b64_tr_b16 v[38:39], v83 offset:608
  s_waitcnt lgkmcnt(0)
  ds_read_b64_tr_b16 v[40:41], v83 offset:4096
  ds_read_b64_tr_b16 v[42:43], v83 offset:4608
  ds_read_b64_tr_b16 v[44:45], v83 offset:4128
  ds_read_b64_tr_b16 v[46:47], v83 offset:4640
  ds_read_b64_tr_b16 v[48:49], v83 offset:4160
  ds_read_b64_tr_b16 v[50:51], v83 offset:4672
  ds_read_b64_tr_b16 v[52:53], v83 offset:4192
  ds_read_b64_tr_b16 v[54:55], v83 offset:4704
  s_waitcnt lgkmcnt(0)
  v_mfma_f32_16x16x32_bf16 v[24:27], v[24:27], v[88:91], 0
  v_mfma_f32_16x16x32_bf16 v[28:31], v[28:31], v[88:91], 0
  v_mfma_f32_16x16x32_bf16 v[32:35], v[32:35], v[88:91], 0
  v_mfma_f32_16x16x32_bf16 v[36:39], v[36:39], v[88:91], 0
  v_mfma_f32_16x16x32_bf16 v[40:43], v[40:43], v[88:91], 0
  v_mfma_f32_16x16x32_bf16 v[44:47], v[44:47], v[88:91], 0
  v_mfma_f32_16x16x32_bf16 v[48:51], v[48:51], v[88:91], 0
  v_mfma_f32_16x16x32_bf16 v[52:55], v[52:55], v[88:91], 0
  v_lshlrev_b32 v9, 8, v2
  v_lshl_add_u32 v9, v3, 4, v9
  s_lshl_b32 s49, s33, 11
  s_add_u32 s49, s49, 23040
  v_add_u32 v9, s49, v9
  s_mov_b32 exec_lo, 0xf000f
  s_mov_b32 exec_hi, 0xf000f
  ds_write_b128 v9, v[24:27] offset:0
  ds_write_b128 v9, v[28:31] offset:64
  ds_write_b128 v9, v[32:35] offset:128
  ds_write_b128 v9, v[36:39] offset:192
  ds_write_b128 v9, v[40:43] offset:1024
  ds_write_b128 v9, v[44:47] offset:1088
  ds_write_b128 v9, v[48:51] offset:1152
  ds_write_b128 v9, v[52:55] offset:1216
  s_mov_b64 exec, -1
  s_mov_b64 exec, 1
  ds_add_u32 v4, v5 offset:12
  s_mov_b64 exec, -1
  s_mov_b32 s53, 400000
L_sync_9:
  ds_read_b32 v9, v4 offset:12
  s_sub_u32 s53, s53, 1
  s_cbranch_scc1 L_sync_9_x
  s_waitcnt lgkmcnt(0)
  v_readfirstlane_b32 s49, v9
  s_nop 0
  s_cmp_ge_u32 s49, 4
  s_cbranch_scc0 L_sync_9
L_sync_9_x:
  s_waitcnt lgkmcnt(0)
  s_lshr_b32 s49, s33, 1
  s_and_b32 s50, s33, 1
  v_bfe_u32 v8, v1, 4, 1
  s_lshl_b32 s51, s50, 1
  v_add_u32 v8, s51, v8
  v_lshlrev_b32 v10, 8, v8
  v_lshl_add_u32 v10, v2, 4, v10
  s_lshl_b32 s51, s49, 10
  s_add_u32 s51, s51, 23040
  v_add_u32 v10, s51, v10
  ds_read_b128 v[24:27], v10 offset:0
  ds_read_b128 v[28:31], v10 offset:2048
  ds_read_b128 v[32:35], v10 offset:4096
  ds_read_b128 v[36:39], v10 offset:6144
  v_lshrrev_b32 v10, 3, v2
  v_mul_u32_u24 v10, 5120, v10
  v_mul_u32_u24 v11, 1280, v8
  v_and_b32 v9, 7, v2
  v_lshlrev_b32 v9, 4, v9
  v_add3_u32 v10, v10, v11, v9
  s_mul_i32 s50, s92, 10240
  s_lshl_b32 s51, s93, 1
  s_add_u32 s51, s51, s49
  s_lshl_b32 s51, s51, 7
  s_add_u32 s50, s50, s51
  s_add_u32 s50, s50, 2097152
  v_add_u32 v10, s50, v10
  s_waitcnt lgkmcnt(0)
  v_add_f32 v24, v24, v28
  v_add_f32 v32, v32, v36
  v_add_f32 v25, v25, v29
  v_add_f32 v33, v33, v37
  v_add_f32 v26, v26, v30
  v_add_f32 v34, v34, v38
  v_add_f32 v27, v27, v31
  v_add_f32 v35, v35, v39
  v_add_f32 v12, v24, v32
  v_add_f32 v13, v25, v33
  v_add_f32 v14, v26, v34
  v_add_f32 v15, v27, v35
  v_add_u32 v12, 0x80, v12
  v_bfi_b32 v12, s3, v6, v12
  v_add_u32 v13, 0x80, v13
  v_bfi_b32 v13, s3, v6, v13
  v_add_u32 v14, 0x80, v14
  v_bfi_b32 v14, s3, v6, v14
  v_add_u32 v15, 0x80, v15
  v_bfi_b32 v15, s3, v6, v15
  s_mov_b64 exec, 1
  ds_add_u32 v4, v5 offset:20
  s_mov_b64 exec, -1
  s_mov_b32 s53, 400000
L_sync_10:
  ds_read_b32 v9, v4 offset:20
  s_sub_u32 s53, s53, 1
  s_cbranch_scc1 L_sync_10_x
  s_waitcnt lgkmcnt(0)
  v_readfirstlane_b32 s49, v9
  s_nop 0
  s_cmp_ge_u32 s49, 4
  s_cbranch_scc0 L_sync_10
L_sync_10_x:
  s_waitcnt lgkmcnt(0)
  s_mov_b32 exec_lo, 0xffffffff
  s_mov_b32 exec_hi, 0x0
  global_store_dwordx4 v10, v[12:15], s[26:27] sc1
  s_mov_b64 exec, -1
L_roleA_done_8:
  s_cmp_ge_u32 s32, 5
  s_cbranch_scc1 L_noproj_11
  s_mul_i32 s49, s29, 163840
  s_lshl_b32 s50, s32, 8
  s_add_u32 s49, s49, s50
  s_add_u32 s36, s12, s49
  s_addc_u32 s37, s13, 0
  s_mov_b32 s38, 163840
  s_mov_b32 s39, 0x20000
  s_sub_u32 s38, 163840, s50
  v_mul_u32_u24 v8, 1280, v3
  v_lshl_add_u32 v8, v2, 4, v8
  s_mul_i32 s51, s33, 40960
  s_lshl_b32 s52, s33, 13
  s_add_u32 s52, s52, 23040
  s_add_u32 m0, s52, 0
  s_add_u32 s50, s51, 0
  buffer_load_dwordx4 v8, s[36:39], s50 offen nt lds
  s_add_u32 m0, s52, 1024
  s_add_u32 s50, s51, 5120
  buffer_load_dwordx4 v8, s[36:39], s50 offen nt lds
  s_waitcnt vmcnt(1)
  s_add_u32 m0, s52, 2048
  s_add_u32 s50, s51, 10240
  buffer_load_dwordx4 v8, s[36:39], s50 offen nt lds
  s_waitcnt vmcnt(1)
  s_add_u32 m0, s52, 3072
  s_add_u32 s50, s51, 15360
  buffer_load_dwordx4 v8, s[36:39], s50 offen nt lds
  s_waitcnt vmcnt(1)
  s_add_u32 m0, s52, 4096
  s_add_u32 s50, s51, 20480
  buffer_load_dwordx4 v8, s[36:39], s50 offen nt lds
  s_waitcnt vmcnt(1)
  s_add_u32 m0, s52, 5120
  s_add_u32 s50, s51, 25600
  buffer_load_dwordx4 v8, s[36:39], s50 offen nt lds
  s_waitcnt vmcnt(1)
  s_add_u32 m0, s52, 6144
  s_add_u32 s50, s51, 30720
  buffer_load_dwordx4 v8, s[36:39], s50 offen nt lds
  s_waitcnt vmcnt(1)
  s_add_u32 m0, s52, 7168
  s_add_u32 s50, s51, 35840
  buffer_load_dwordx4 v8, s[36:39], s50 offen nt lds
  s_waitcnt vmcnt(0)
  s_mov_b64 exec, 1
  ds_add_u32 v4, v5 offset:8
  s_mov_b64 exec, -1
  s_mov_b32 s53, 400000
L_sync_12:
  ds_read_b32 v9, v4 offset:8
  s_sub_u32 s53, s53, 1
  s_cbranch_scc1 L_sync_12_x
  s_waitcnt lgkmcnt(0)
  v_readfirstlane_b32 s49, v9
  s_nop 0
  s_cmp_ge_u32 s49, 4
  s_cbranch_scc0 L_sync_12
L_sync_12_x:
  s_waitcnt lgkmcnt(0)
  ds_read_b64_tr_b16 v[96:97], v92 offset:0
  ds_read_b64_tr_b16 v[98:99], v92 offset:256
  ds_read_b64_tr_b16 v[100:101], v92 offset:8192
  ds_read_b64_tr_b16 v[102:103], v92 offset:8448
  ds_read_b64_tr_b16 v[104:105], v92 offset:16384
  ds_read_b64_tr_b16 v[106:107], v92 offset:16640
  ds_read_b64_tr_b16 v[108:109], v92 offset:24576
  ds_read_b64_tr_b16 v[110:111], v92 offset:24832
  ds_read_b64_tr_b16 v[112:113], v92 offset:32
  ds_read_b64_tr_b16 v[114:115], v92 offset:288
  ds_read_b64_tr_b16 v[116:117], v92 offset:8224
  ds_read_b64_tr_b16 v[118:119], v92 offset:8480
  ds_read_b64_tr_b16 v[120:121], v92 offset:16416
  ds_read_b64_tr_b16 v[122:123], v92 offset:16672
  ds_read_b64_tr_b16 v[124:125], v92 offset:24608
  ds_read_b64_tr_b16 v[126:127], v92 offset:24864
  s_waitcnt lgkmcnt(0)
L_noproj_11:
  s_cmp_lg_u32 s35, 2
  s_cbranch_scc1 L_roleB_done_13
  s_mul_i32 s49, s59, 40960
  s_mul_i32 s50, s33, 320
  s_add_u32 s49, s49, s50
  s_add_u32 s36, s20, s49
  s_addc_u32 s37, s21, 0
  s_mov_b32 s38, 40960
  s_mov_b32 s39, 0x20000
  s_sub_u32 s38, 40960, s50
  s_mov_b32 s51, 0
  s_add_u32 m0, s58, 0
  s_mov_b32 s48, s51
  buffer_load_dwordx4 v64, s[36:39], s48 offen nt lds
  s_add_u32 m0, s58, 1024
  s_nop 0
  buffer_load_dwordx4 v65, s[36:39], s48 offen nt lds
  s_waitcnt vmcnt(1)
  s_add_u32 m0, s58, 2048
  s_nop 0
  buffer_load_dwordx4 v66, s[36:39], s48 offen nt lds
  s_waitcnt vmcnt(1)
  s_add_u32 m0, s58, 3072
  s_nop 0
  buffer_load_dwordx4 v67, s[36:39], s48 offen nt lds
  s_waitcnt vmcnt(1)
  s_add_u32 m0, s58, 4096
  s_nop 0
  buffer_load_dwordx4 v68, s[36:39], s48 offen nt lds
  s_waitcnt vmcnt(1)
  s_add_u32 m0, s58, 5120
  s_add_u32 s48, s51, 20480
  buffer_load_dwordx4 v64, s[36:39], s48 offen nt lds
  s_waitcnt vmcnt(1)
  s_add_u32 m0, s58, 6144
  s_nop 0
  buffer_load_dwordx4 v65, s[36:39], s48 offen nt lds
  s_waitcnt vmcnt(1)
  s_add_u32 m0, s58, 7168
  s_nop 0
  buffer_load_dwordx4 v66, s[36:39], s48 offen nt lds
  s_waitcnt vmcnt(1)
  s_add_u32 m0, s58, 8192
  s_nop 0
  buffer_load_dwordx4 v67, s[36:39], s48 offen nt lds
  s_waitcnt vmcnt(1)
  s_add_u32 m0, s58, 9216
  s_nop 0
  buffer_load_dwordx4 v68, s[36:39], s48 offen nt lds
  s_waitcnt vmcnt(0)
  ds_read_b64_tr_b16 v[24:25], v69 offset:0
  ds_read_b64_tr_b16 v[26:27], v69 offset:1280
  ds_read_b64_tr_b16 v[28:29], v69 offset:32
  ds_read_b64_tr_b16 v[30:31], v69 offset:1312
  ds_read_b64_tr_b16 v[32:33], v69 offset:64
  ds_read_b64_tr_b16 v[34:35], v69 offset:1344
  ds_read_b64_tr_b16 v[36:37], v69 offset:96
  ds_read_b64_tr_b16 v[38:39], v69 offset:1376
  ds_read_b64_tr_b16 v[40:41], v69 offset:128
  ds_read_b64_tr_b16 v[42:43], v69 offset:1408
  ds_read_b64_tr_b16 v[44:45], v69 offset:160
  ds_read_b64_tr_b16 v[46:47], v69 offset:1440
  ds_read_b64_tr_b16 v[48:49], v69 offset:192
  ds_read_b64_tr_b16 v[50:51], v69 offset:1472
  ds_read_b64_tr_b16 v[52:53], v69 offset:224
  ds_read_b64_tr_b16 v[54:55], v69 offset:1504
  ds_read_b64_tr_b16 v[56:57], v69 offset:256
  ds_read_b64_tr_b16 v[58:59], v69 offset:1536
  ds_read_b64_tr_b16 v[60:61], v69 offset:288
  ds_read_b64_tr_b16 v[62:63], v69 offset:1568
  s_waitcnt lgkmcnt(0)
  s_mul_i32 s49, s59, 5120
  s_mul_i32 s50, s33, 1280
  s_add_u32 s49, s49, s50
  s_add_u32 s49, s49, 2097152
  v_lshlrev_b32 v8, 4, v1
  v_add_u32 v8, s49, v8
  s_mov_b32 s53, 3200000
L_prog_14:
  ds_read_b32 v11, v4 offset:16
  s_sub_u32 s53, s53, 1
  s_cbranch_scc1 L_prog_14_x
  s_waitcnt lgkmcnt(0)
  v_readfirstlane_b32 s49, v11
  s_nop 0
  s_cmp_ge_u32 s49, 1
  s_cbranch_scc1 L_prog_14_x
  s_sleep 8
  s_branch L_prog_14
L_prog_14_x:
  s_waitcnt lgkmcnt(0)
  s_mov_b32 s53, 400000
L_f1poll_15:
  v_mov_b32 v16, v87
  v_mov_b32 v17, v87
  v_mov_b32 v18, v87
  v_mov_b32 v19, v87
  global_load_dwordx4 v[12:15], v8, s[26:27] sc1
  s_mov_b32 exec_lo, 0xffff
  s_mov_b32 exec_hi, 0x0
  global_load_dwordx4 v[16:19], v8, s[26:27] offset:1024 sc1
  s_mov_b64 exec, -1
  s_sub_u32 s53, s53, 1
  s_cbranch_scc1 L_f1poll_15_x
  s_waitcnt vmcnt(0)
  v_xor_b32 v12, v12, v87
  v_xor_b32 v13, v13, v87
  v_xor_b32 v14, v14, v87
  v_xor_b32 v15, v15, v87
  v_xor_b32 v16, v16, v87
  v_xor_b32 v17, v17, v87
  v_xor_b32 v18, v18, v87
  v_xor_b32 v19, v19, v87
  v_or_b32 v9, v12, v13
  v_or3_b32 v9, v9, v14, v15
  v_or3_b32 v9, v9, v16, v17
  v_or3_b32 v9, v9, v18, v19
  v_and_b32 v9, 0xff, v9
  v_cmp_ne_u32 vcc, 0, v9
  s_nop 0
  s_cbranch_vccz L_f1poll_15_x
  s_sleep 48
  s_branch L_f1poll_15
L_f1poll_15_x:
  s_waitcnt vmcnt(0)
  v_add_f32 v12, v12, v16
  v_add_f32 v13, v13, v17
  v_add_f32 v14, v14, v18
  v_add_f32 v15, v15, v19
  v_mov_b32 v16, v12
  v_mov_b32 v17, v13
  v_mov_b32 v18, v14
  v_mov_b32 v19, v15
  v_permlane16_swap_b32 v16, v12
  v_permlane16_swap_b32 v17, v13
  v_permlane16_swap_b32 v18, v14
  v_permlane16_swap_b32 v19, v15
  v_add_f32 v12, v12, v16
  v_add_f32 v13, v13, v17
  v_add_f32 v14, v14, v18
  v_add_f32 v15, v15, v19
  v_mov_b32 v16, v12
  v_mov_b32 v17, v13
  v_mov_b32 v18, v14
  v_mov_b32 v19, v15
  v_permlane32_swap_b32 v16, v12
  v_permlane32_swap_b32 v17, v13
  v_permlane32_swap_b32 v18, v14
  v_permlane32_swap_b32 v19, v15
  v_add_f32 v12, v12, v16
  v_add_f32 v13, v13, v17
  v_add_f32 v14, v14, v18
  v_add_f32 v15, v15, v19
  v_mov_b32_dpp v16, v12 row_ror:8 row_mask:0xf bank_mask:0xf
  v_mov_b32_dpp v17, v13 row_ror:8 row_mask:0xf bank_mask:0xf
  v_mov_b32_dpp v18, v14 row_ror:8 row_mask:0xf bank_mask:0xf
  v_mov_b32_dpp v19, v15 row_ror:8 row_mask:0xf bank_mask:0xf
  v_cvt_pk_bf16_f32 v12, v12, v12
  v_and_b32 v12, 0xffff0000, v12
  v_cvt_pk_bf16_f32 v16, v16, v16
  v_and_b32 v16, 0xffff0000, v16
  v_mul_f32 v10, v12, v12
  v_mul_f32 v10, v10, v12
  v_mov_b32 v11, 0x3d372713
  v_fma_f32 v10, v10, v11, v12
  v_mul_f32 v10, 0xc0135761, v10
  v_exp_f32 v10, v10
  s_nop 0
  v_add_f32 v10, 1.0, v10
  v_rcp_f32 v10, v10
  s_nop 0
  v_mul_f32 v12, v12, v10
  v_cvt_pk_bf16_f32 v12, v12, v12
  v_and_b32 v12, 0xffff0000, v12
  v_mul_f32 v12, v12, v16
  v_cvt_pk_bf16_f32 v13, v13, v13
  v_and_b32 v13, 0xffff0000, v13
  v_cvt_pk_bf16_f32 v17, v17, v17
  v_and_b32 v17, 0xffff0000, v17
  v_mul_f32 v10, v13, v13
  v_mul_f32 v10, v10, v13
  v_mov_b32 v11, 0x3d372713
  v_fma_f32 v10, v10, v11, v13
  v_mul_f32 v10, 0xc0135761, v10
  v_exp_f32 v10, v10
  s_nop 0
  v_add_f32 v10, 1.0, v10
  v_rcp_f32 v10, v10
  s_nop 0
  v_mul_f32 v13, v13, v10
  v_cvt_pk_bf16_f32 v13, v13, v13
  v_and_b32 v13, 0xffff0000, v13
  v_mul_f32 v13, v13, v17
  v_cvt_pk_bf16_f32 v14, v14, v14
  v_and_b32 v14, 0xffff0000, v14
  v_cvt_pk_bf16_f32 v18, v18, v18
  v_and_b32 v18, 0xffff0000, v18
  v_mul_f32 v10, v14, v14
  v_mul_f32 v10, v10, v14
  v_mov_b32 v11, 0x3d372713
  v_fma_f32 v10, v10, v11, v14
  v_mul_f32 v10, 0xc0135761, v10
  v_exp_f32 v10, v10
  s_nop 0
  v_add_f32 v10, 1.0, v10
  v_rcp_f32 v10, v10
  s_nop 0
  v_mul_f32 v14, v14, v10
  v_cvt_pk_bf16_f32 v14, v14, v14
  v_and_b32 v14, 0xffff0000, v14
  v_mul_f32 v14, v14, v18
  v_cvt_pk_bf16_f32 v15, v15, v15
  v_and_b32 v15, 0xffff0000, v15
  v_cvt_pk_bf16_f32 v19, v19, v19
  v_and_b32 v19, 0xffff0000, v19
  v_mul_f32 v10, v15, v15
  v_mul_f32 v10, v10, v15
  v_mov_b32 v11, 0x3d372713
  v_fma_f32 v10, v10, v11, v15
  v_mul_f32 v10, 0xc0135761, v10
  v_exp_f32 v10, v10
  s_nop 0
  v_add_f32 v10, 1.0, v10
  v_rcp_f32 v10, v10
  s_nop 0
  v_mul_f32 v15, v15, v10
  v_cvt_pk_bf16_f32 v15, v15, v15
  v_and_b32 v15, 0xffff0000, v15
  v_mul_f32 v15, v15, v19
  v_cvt_pk_bf16_f32 v12, v12, v13
  v_cvt_pk_bf16_f32 v13, v14, v15
  s_lshl_b32 s49, s33, 6
  s_add_u32 s49, s49, 16384
  v_and_b32 v9, 7, v1
  v_lshlrev_b32 v9, 3, v9
  v_add_u32 v9, s49, v9
  s_mov_b32 exec_lo, 0xff
  s_mov_b32 exec_hi, 0x0
  ds_write_b64 v9, v[12:13]
  s_mov_b64 exec, -1
  s_mov_b64 exec, 1
  ds_add_u32 v4, v5 offset:12
  s_mov_b64 exec, -1
  s_mov_b32 s53, 400000
L_sync_16:
  ds_read_b32 v9, v4 offset:12
  s_sub_u32 s53, s53, 1
  s_cbranch_scc1 L_sync_16_x
  s_waitcnt lgkmcnt(0)
  v_readfirstlane_b32 s49, v9
  s_nop 0
  s_cmp_ge_u32 s49, 4
  s_cbranch_scc0 L_sync_16
L_sync_16_x:
  s_waitcnt lgkmcnt(0)
  v_and_b32 v9, 3, v2
  v_lshlrev_b32 v9, 6, v9
  v_lshl_add_u32 v9, v3, 4, v9
  v_add_u32 v9, 16384, v9
  ds_read_b128 v[88:91], v9
  v_mul_u32_u24 v10, 163840, v2
  v_lshl_add_u32 v10, v3, 4, v10
  s_lshl_b32 s49, s59, 6
  v_add_u32 v10, s49, v10
  v_mov_b32 v11, 0x80000000
  v_cmp_gt_u32 vcc, 4, v2
  s_nop 1
  v_cndmask_b32 v10, v11, v10, vcc
  s_mov_b32 s49, 1048576
  s_add_u32 s40, s26, s49
  s_addc_u32 s41, s27, 0
  s_mov_b32 s42, 655360
  s_mov_b32 s43, 0x20000
  s_mul_i32 s48, s33, 40960
  s_waitcnt lgkmcnt(0)
  v_mfma_f32_16x16x32_bf16 v[24:27], v[24:27], v[88:91], 0
  v_mfma_f32_16x16x32_bf16 v[28:31], v[28:31], v[88:91], 0
  v_mfma_f32_16x16x32_bf16 v[32:35], v[32:35], v[88:91], 0
  v_mfma_f32_16x16x32_bf16 v[36:39], v[36:39], v[88:91], 0
  v_mfma_f32_16x16x32_bf16 v[40:43], v[40:43], v[88:91], 0
  v_mfma_f32_16x16x32_bf16 v[44:47], v[44:47], v[88:91], 0
  v_mfma_f32_16x16x32_bf16 v[48:51], v[48:51], v[88:91], 0
  v_mfma_f32_16x16x32_bf16 v[52:55], v[52:55], v[88:91], 0
  v_mfma_f32_16x16x32_bf16 v[56:59], v[56:59], v[88:91], 0
  v_mfma_f32_16x16x32_bf16 v[60:63], v[60:63], v[88:91], 0
  v_add_u32 v24, 0x80, v24
  v_bfi_b32 v24, s3, v6, v24
  v_add_u32 v25, 0x80, v25
  v_bfi_b32 v25, s3, v6, v25
  v_add_u32 v26, 0x80, v26
  v_bfi_b32 v26, s3, v6, v26
  v_add_u32 v27, 0x80, v27
  v_bfi_b32 v27, s3, v6, v27
  buffer_store_dwordx4 v[24:27], v10, s[40:43], s48 offen sc1
  s_add_u32 s48, s48, 4096
  v_add_u32 v28, 0x80, v28
  v_bfi_b32 v28, s3, v6, v28
  v_add_u32 v29, 0x80, v29
  v_bfi_b32 v29, s3, v6, v29
  v_add_u32 v30, 0x80, v30
  v_bfi_b32 v30, s3, v6, v30
  v_add_u32 v31, 0x80, v31
  v_bfi_b32 v31, s3, v6, v31
  buffer_store_dwordx4 v[28:31], v10, s[40:43], s48 offen sc1
  s_add_u32 s48, s48, 4096
  v_add_u32 v32, 0x80, v32
  v_bfi_b32 v32, s3, v6, v32
  v_add_u32 v33, 0x80, v33
  v_bfi_b32 v33, s3, v6, v33
  v_add_u32 v34, 0x80, v34
  v_bfi_b32 v34, s3, v6, v34
  v_add_u32 v35, 0x80, v35
  v_bfi_b32 v35, s3, v6, v35
  buffer_store_dwordx4 v[32:35], v10, s[40:43], s48 offen sc1
  s_add_u32 s48, s48, 4096
  v_add_u32 v36, 0x80, v36
  v_bfi_b32 v36, s3, v6, v36
  v_add_u32 v37, 0x80, v37
  v_bfi_b32 v37, s3, v6, v37
  v_add_u32 v38, 0x80, v38
  v_bfi_b32 v38, s3, v6, v38
  v_add_u32 v39, 0x80, v39
  v_bfi_b32 v39, s3, v6, v39
  buffer_store_dwordx4 v[36:39], v10, s[40:43], s48 offen sc1
  s_add_u32 s48, s48, 4096
  v_add_u32 v40, 0x80, v40
  v_bfi_b32 v40, s3, v6, v40
  v_add_u32 v41, 0x80, v41
  v_bfi_b32 v41, s3, v6, v41
  v_add_u32 v42, 0x80, v42
  v_bfi_b32 v42, s3, v6, v42
  v_add_u32 v43, 0x80, v43
  v_bfi_b32 v43, s3, v6, v43
  buffer_store_dwordx4 v[40:43], v10, s[40:43], s48 offen sc1
  s_add_u32 s48, s48, 4096
  v_add_u32 v44, 0x80, v44
  v_bfi_b32 v44, s3, v6, v44
  v_add_u32 v45, 0x80, v45
  v_bfi_b32 v45, s3, v6, v45
  v_add_u32 v46, 0x80, v46
  v_bfi_b32 v46, s3, v6, v46
  v_add_u32 v47, 0x80, v47
  v_bfi_b32 v47, s3, v6, v47
  buffer_store_dwordx4 v[44:47], v10, s[40:43], s48 offen sc1
  s_add_u32 s48, s48, 4096
  v_add_u32 v48, 0x80, v48
  v_bfi_b32 v48, s3, v6, v48
  v_add_u32 v49, 0x80, v49
  v_bfi_b32 v49, s3, v6, v49
  v_add_u32 v50, 0x80, v50
  v_bfi_b32 v50, s3, v6, v50
  v_add_u32 v51, 0x80, v51
  v_bfi_b32 v51, s3, v6, v51
  buffer_store_dwordx4 v[48:51], v10, s[40:43], s48 offen sc1
  s_add_u32 s48, s48, 4096
  v_add_u32 v52, 0x80, v52
  v_bfi_b32 v52, s3, v6, v52
  v_add_u32 v53, 0x80, v53
  v_bfi_b32 v53, s3, v6, v53
  v_add_u32 v54, 0x80, v54
  v_bfi_b32 v54, s3, v6, v54
  v_add_u32 v55, 0x80, v55
  v_bfi_b32 v55, s3, v6, v55
  buffer_store_dwordx4 v[52:55], v10, s[40:43], s48 offen sc1
  s_add_u32 s48, s48, 4096
  v_add_u32 v56, 0x80, v56
  v_bfi_b32 v56, s3, v6, v56
  v_add_u32 v57, 0x80, v57
  v_bfi_b32 v57, s3, v6, v57
  v_add_u32 v58, 0x80, v58
  v_bfi_b32 v58, s3, v6, v58
  v_add_u32 v59, 0x80, v59
  v_bfi_b32 v59, s3, v6, v59
  buffer_store_dwordx4 v[56:59], v10, s[40:43], s48 offen sc1
  s_add_u32 s48, s48, 4096
  v_add_u32 v60, 0x80, v60
  v_bfi_b32 v60, s3, v6, v60
  v_add_u32 v61, 0x80, v61
  v_bfi_b32 v61, s3, v6, v61
  v_add_u32 v62, 0x80, v62
  v_bfi_b32 v62, s3, v6, v62
  v_add_u32 v63, 0x80, v63
  v_bfi_b32 v63, s3, v6, v63
  buffer_store_dwordx4 v[60:63], v10, s[40:43], s48 offen sc1
L_roleB_done_13:
  s_cmp_lg_u32 s33, 0
  s_cbranch_scc1 L_nostat_17
  v_mov_b32 v8, 14144
  s_mov_b32 s53, 3200000
L_stat_18:
  ds_read_b128 v[12:15], v8
  ds_read_b128 v[16:19], v8 offset:16
  s_sub_u32 s53, s53, 1
  s_cbranch_scc1 L_stat_18_x
  s_waitcnt lgkmcnt(0)
  v_max3_u32 v9, v13, v15, v17
  v_max_u32 v9, v9, v19
  v_cmp_eq_u32 vcc, -1, v9
  s_nop 0
  s_cbranch_vccz L_stat_18_x
  s_sleep 8
  s_branch L_stat_18
L_stat_18_x:
  s_waitcnt lgkmcnt(0)
  v_max3_f32 v9, v12, v14, v16
  v_max_f32 v9, v9, v18
  v_mov_b32 v10, 0
  v_sub_f32 v12, v12, v9
  v_exp_f32 v12, v12
  s_nop 0
  v_fmac_f32 v10, v12, v13
  v_sub_f32 v14, v14, v9
  v_exp_f32 v14, v14
  s_nop 0
  v_fmac_f32 v10, v14, v15
  v_sub_f32 v16, v16, v9
  v_exp_f32 v16, v16
  s_nop 0
  v_fmac_f32 v10, v16, v17
  v_sub_f32 v18, v18, v9
  v_exp_f32 v18, v18
  s_nop 0
  v_fmac_f32 v10, v18, v19
  v_mov_b32 v12, v9
  v_mov_b32 v13, v6
  v_mov_b32 v14, v10
  v_mov_b32 v15, v6
  s_lshl_b32 s49, s29, 3
  s_add_u32 s49, s49, s32
  s_lshl_b32 s49, s49, 4
  s_add_u32 s49, s49, 3670016
  v_mov_b32 v8, s49
  s_mov_b64 exec, 1
  global_store_dwordx4 v8, v[12:15], s[26:27] sc1
  s_mov_b64 exec, -1
  s_cmp_lg_u32 s2, 0
  s_cbranch_scc1 L_nostat_17
  v_lshlrev_b32 v8, 4, v1
  v_add_u32 v8, 3932160, v8
  s_mov_b32 s53, 400000
L_cipoll_19:
  global_load_dwordx4 v[12:15], v8, s[26:27] sc1
  s_sub_u32 s53, s53, 1
  s_cbranch_scc1 L_cipoll_19_x
  s_waitcnt vmcnt(0)
  v_xor_b32 v9, v12, v6
  v_bitop3_b32 v9, v9, v13, v6 bitop3:0xf6
  v_bitop3_b32 v9, v9, v14, v6 bitop3:0xf6
  v_bitop3_b32 v9, v9, v15, v6 bitop3:0xf6
  v_cmp_ne_u32 vcc, 0, v9
  s_nop 0
  s_cbranch_vccz L_cipoll_19_x
  s_sleep 48
  s_branch L_cipoll_19
L_cipoll_19_x:
  s_waitcnt vmcnt(0)
  v_mov_b32 v8, 4194304
  s_mov_b64 exec, 1
  global_store_dword v8, v6, s[26:27] sc1
  s_mov_b64 exec, -1
L_nostat_17:
  s_cmp_lg_u32 s35, 3
  s_cbranch_scc1 L_nocons_20
  s_mul_i32 s92, s33, 40
  s_add_u32 s92, s92, s59
  s_lshl_b32 s49, s92, 12
  s_add_u32 s49, s49, 1048576
  v_lshlrev_b32 v9, 4, v1
  v_add_u32 v8, s49, v9
  s_lshl_b32 s49, s92, 11
  v_add_u32 v85, s49, v9
  v_and_b32 v10, 3, v1
  v_lshlrev_b32 v10, 3, v10
  s_mul_i32 s49, s33, 1280
  s_lshl_b32 s50, s59, 5
  s_add_u32 s49, s49, s50
  v_add_u32 v84, s49, v10
  global_load_dwordx2 v[48:49], v84, s[4:5]
  s_mov_b32 s53, 3200000
L_prog_21:
  ds_read_b32 v11, v4 offset:16
  s_sub_u32 s53, s53, 1
  s_cbranch_scc1 L_prog_21_x
  s_waitcnt lgkmcnt(0)
  v_readfirstlane_b32 s49, v11
  s_nop 0
  s_cmp_ge_u32 s49, 2
  s_cbranch_scc1 L_prog_21_x
  s_sleep 8
  s_branch L_prog_21
L_prog_21_x:
  s_waitcnt lgkmcnt(0)
  s_mov_b32 s53, 400000
L_dpoll_22:
  v_mov_b32 v44, v87
  v_mov_b32 v45, v87
  v_mov_b32 v46, v87
  v_mov_b32 v47, v87
  global_load_dwordx4 v[32:35], v8, s[26:27] offset:0 sc1
  global_load_dwordx4 v[36:39], v8, s[26:27] offset:1024 sc1
  global_load_dwordx4 v[40:43], v8, s[26:27] offset:2048 sc1
  s_mov_b32 exec_lo, 0xffffff
  s_mov_b32 exec_hi, 0x0
  global_load_dwordx4 v[44:47], v8, s[26:27] offset:3072 sc1
  s_mov_b64 exec, -1
  s_sub_u32 s53, s53, 1
  s_cbranch_scc1 L_dpoll_22_x
  s_waitcnt vmcnt(0)
  v_xor_b32 v32, v32, v87
  v_xor_b32 v33, v33, v87
  v_xor_b32 v34, v34, v87
  v_xor_b32 v35, v35, v87
  v_xor_b32 v36, v36, v87
  v_xor_b32 v37, v37, v87
  v_xor_b32 v38, v38, v87
  v_xor_b32 v39, v39, v87
  v_xor_b32 v40, v40, v87
  v_xor_b32 v41, v41, v87
  v_xor_b32 v42, v42, v87
  v_xor_b32 v43, v43, v87
  v_xor_b32 v44, v44, v87
  v_xor_b32 v45, v45, v87
  v_xor_b32 v46, v46, v87
  v_xor_b32 v47, v47, v87
  v_or_b32 v11, v32, v33
  v_or3_b32 v11, v11, v34, v35
  v_or3_b32 v11, v11, v36, v37
  v_or3_b32 v11, v11, v38, v39
  v_or3_b32 v11, v11, v40, v41
  v_or3_b32 v11, v11, v42, v43
  v_or3_b32 v11, v11, v44, v45
  v_or3_b32 v11, v11, v46, v47
  v_and_b32 v11, 0xff, v11
  v_cmp_ne_u32 vcc, 0, v11
  s_nop 0
  s_cbranch_vccz L_dpoll_22_x
  s_sleep 48
  s_branch L_dpoll_22
L_dpoll_22_x:
  s_waitcnt vmcnt(0)
  v_lshlrev_b32 v78, 16, v48
  v_and_b32 v79, 0xffff0000, v48
  v_lshlrev_b32 v80, 16, v49
  v_and_b32 v81, 0xffff0000, v49
  v_add_f32 v32, v32, v36
  v_add_f32 v33, v33, v37
  v_add_f32 v34, v34, v38
  v_add_f32 v35, v35, v39
  v_add_f32 v32, v32, v40
  v_add_f32 v33, v33, v41
  v_add_f32 v34, v34, v42
  v_add_f32 v35, v35, v43
  v_add_f32 v32, v32, v44
  v_add_f32 v33, v33, v45
  v_add_f32 v34, v34, v46
  v_add_f32 v35, v35, v47
  v_add_f32_dpp v32, v32, v32 row_ror:4 row_mask:0xf bank_mask:0xf
  v_add_f32_dpp v33, v33, v33 row_ror:4 row_mask:0xf bank_mask:0xf
  v_add_f32_dpp v34, v34, v34 row_ror:4 row_mask:0xf bank_mask:0xf
  v_add_f32_dpp v35, v35, v35 row_ror:4 row_mask:0xf bank_mask:0xf
  v_add_f32_dpp v32, v32, v32 row_ror:8 row_mask:0xf bank_mask:0xf
  v_add_f32_dpp v33, v33, v33 row_ror:8 row_mask:0xf bank_mask:0xf
  v_add_f32_dpp v34, v34, v34 row_ror:8 row_mask:0xf bank_mask:0xf
  v_add_f32_dpp v35, v35, v35 row_ror:8 row_mask:0xf bank_mask:0xf
  v_mov_b32 v36, v32
  v_mov_b32 v37, v33
  v_mov_b32 v38, v34
  v_mov_b32 v39, v35
  v_permlane16_swap_b32 v36, v32
  v_permlane16_swap_b32 v37, v33
  v_permlane16_swap_b32 v38, v34
  v_permlane16_swap_b32 v39, v35
  v_add_f32 v32, v32, v36
  v_add_f32 v33, v33, v37
  v_add_f32 v34, v34, v38
  v_add_f32 v35, v35, v39
  v_mov_b32 v36, v32
  v_mov_b32 v37, v33
  v_mov_b32 v38, v34
  v_mov_b32 v39, v35
  v_permlane32_swap_b32 v36, v32
  v_permlane32_swap_b32 v37, v33
  v_permlane32_swap_b32 v38, v34
  v_permlane32_swap_b32 v39, v35
  v_add_f32 v32, v32, v36
  v_add_f32 v33, v33, v37
  v_add_f32 v34, v34, v38
  v_add_f32 v35, v35, v39
  v_cvt_pk_bf16_f32 v32, v32, v32
  v_and_b32 v32, 0xffff0000, v32
  v_mul_f32 v36, 0xbfb8aa3b, v32
  v_exp_f32 v36, v36
  s_nop 0
  v_add_f32 v36, 1.0, v36
  v_rcp_f32 v36, v36
  s_nop 0
  v_mul_f32 v32, v32, v36
  v_cvt_pk_bf16_f32 v74, v32, v32
  v_and_b32 v74, 0xffff0000, v74
  v_cvt_pk_bf16_f32 v33, v33, v33
  v_and_b32 v33, 0xffff0000, v33
  v_mul_f32 v37, 0xbfb8aa3b, v33
  v_exp_f32 v37, v37
  s_nop 0
  v_add_f32 v37, 1.0, v37
  v_rcp_f32 v37, v37
  s_nop 0
  v_mul_f32 v33, v33, v37
  v_cvt_pk_bf16_f32 v75, v33, v33
  v_and_b32 v75, 0xffff0000, v75
  v_cvt_pk_bf16_f32 v34, v34, v34
  v_and_b32 v34, 0xffff0000, v34
  v_mul_f32 v38, 0xbfb8aa3b, v34
  v_exp_f32 v38, v38
  s_nop 0
  v_add_f32 v38, 1.0, v38
  v_rcp_f32 v38, v38
  s_nop 0
  v_mul_f32 v34, v34, v38
  v_cvt_pk_bf16_f32 v76, v34, v34
  v_and_b32 v76, 0xffff0000, v76
  v_cvt_pk_bf16_f32 v35, v35, v35
  v_and_b32 v35, 0xffff0000, v35
  v_mul_f32 v39, 0xbfb8aa3b, v35
  v_exp_f32 v39, v39
  s_nop 0
  v_add_f32 v39, 1.0, v39
  v_rcp_f32 v39, v39
  s_nop 0
  v_mul_f32 v35, v35, v39
  v_cvt_pk_bf16_f32 v77, v35, v35
  v_and_b32 v77, 0xffff0000, v77
L_nocons_20:
  s_cmp_lg_u32 s33, 0
  s_cbranch_scc1 L_noweight_23
  s_mov_b32 s53, 3200000
L_prog_24:
  ds_read_b32 v11, v4 offset:16
  s_sub_u32 s53, s53, 1
  s_cbranch_scc1 L_prog_24_x
  s_waitcnt lgkmcnt(0)
  v_readfirstlane_b32 s49, v11
  s_nop 0
  s_cmp_ge_u32 s49, 3
  s_cbranch_scc1 L_prog_24_x
  s_sleep 8
  s_branch L_prog_24
L_prog_24_x:
  s_waitcnt lgkmcnt(0)
  s_lshl_b32 s49, s29, 3
  s_and_b32 s50, s32, 6
  s_add_u32 s49, s49, s50
  s_lshl_b32 s49, s49, 4
  s_add_u32 s49, s49, 3670016
  v_mov_b32 v8, s49
  s_mov_b32 s53, 400000
L_stpoll_25:
  global_load_dwordx4 v[32:35], v8, s[26:27] sc1
  global_load_dwordx4 v[36:39], v8, s[26:27] offset:16 sc1
  s_sub_u32 s53, s53, 1
  s_cbranch_scc1 L_stpoll_25_x
  s_waitcnt vmcnt(0)
  v_xor_b32 v11, v33, v6
  v_bitop3_b32 v11, v11, v35, v6 bitop3:0xf6
  v_bitop3_b32 v11, v11, v37, v6 bitop3:0xf6
  v_bitop3_b32 v11, v11, v39, v6 bitop3:0xf6
  v_cmp_ne_u32 vcc, 0, v11
  s_nop 0
  s_cbranch_vccz L_stpoll_25_x
  s_sleep 48
  s_branch L_stpoll_25
L_stpoll_25_x:
  s_waitcnt vmcnt(0)
  v_max_f32 v12, v32, v36
  v_sub_f32 v32, v32, v12
  v_sub_f32 v36, v36, v12
  v_exp_f32 v32, v32
  v_exp_f32 v36, v36
  v_mul_f32 v13, v32, v34
  v_fmac_f32 v13, v36, v38
  v_rcp_f32 v13, v13
  s_cmp_eq_u32 s30, 1
  s_cselect_b64 vcc, -1, 0
  v_cndmask_b32 v32, v32, v36, vcc
  v_mul_f32 v70, v32, v13
  v_and_b32 v8, 7, v1
  v_lshlrev_b32 v8, 2, v8
  s_lshl_b32 s49, s29, 5
  s_add_u32 s49, s49, 3997696
  v_add_u32 v8, s49, v8
  s_mov_b32 s53, 400000
  s_mov_b32 s15, 0
L_xcpoll_26:
  global_load_dword v9, v8, s[26:27] sc1
  s_sub_u32 s53, s53, 1
  s_cbranch_scc1 L_xcpoll_26_x
  s_waitcnt vmcnt(0)
  v_sub_u32 v9, v9, v6
  v_and_b32 v10, 0x0fffffff, v9
  v_cmp_ne_u32 vcc, 0, v10
  s_nop 0
  s_cbranch_vccz L_xcpoll_26_ok
  s_sleep 48
  s_branch L_xcpoll_26
L_xcpoll_26_ok:
  v_lshrrev_b32 v9, 28, v9
  v_cmp_ne_u32 vcc, s14, v9
  s_nop 0
  s_cmp_eq_u64 vcc, 0
  s_cselect_b32 s15, 1, 0
L_xcpoll_26_x:
  s_waitcnt vmcnt(0)
L_noweight_23:
  s_cmp_ge_u32 s32, 5
  s_cbranch_scc1 L_noproj2_27
  s_lshl_b32 s49, s29, 12
  s_add_u32 s49, s49, 3735552
  v_lshlrev_b32 v93, 4, v1
  v_add_u32 v93, s49, v93
  s_lshl_b32 s49, s33, 10
  s_add_u32 s49, s49, 16896
  v_and_b32 v8, 31, v1
  v_lshlrev_b32 v8, 3, v8
  v_lshrrev_b32 v9, 5, v1
  v_lshl_add_u32 v8, v9, 8, v8
  v_add_u32 v94, s49, v8
  v_and_b32 v8, 3, v2
  v_lshlrev_b32 v8, 8, v8
  v_lshl_add_u32 v8, v3, 4, v8
  v_add_u32 v95, s49, v8
  v_mul_u32_u24 v82, 81920, v2
  v_lshl_add_u32 v82, v3, 4, v82
  s_lshl_b32 s49, s29, 6
  v_add_u32 v82, s49, v82
  v_mov_b32 v11, 0x80000000
  v_cmp_gt_u32 vcc, 4, v2
  s_nop 1
  v_cndmask_b32 v82, v11, v82, vcc
L_noproj2_27:
  s_mov_b32 s49, 0
  s_add_u32 s40, s26, s49
  s_addc_u32 s41, s27, 0
  s_mov_b32 s42, 327680
  s_mov_b32 s43, 0x20000
  s_lshl_b32 s48, s32, 3
  s_lshl_b32 s49, s33, 1
  s_add_u32 s48, s48, s49
  s_lshl_b32 s48, s48, 11
  v_and_b32 v9, 31, v1
  v_lshlrev_b32 v9, 4, v9
  v_add_u32 v86, 20992, v9
  s_lshl_b32 s49, s29, 1
  s_add_u32 s49, s49, s30
  s_lshl_b32 s49, s49, 2
  s_add_u32 s49, s49, s31
  s_lshl_b32 s49, s49, 9
  s_add_u32 s49, s49, 3735552
  v_add_u32 v66, s49, v9
  s_waitcnt vmcnt(0)
  s_barrier
  s_cmp_lg_u32 s33, 0
  s_cbranch_scc1 L_noopub_28
  ds_read_b128 v[24:27], v86 offset:0
  ds_read_b128 v[28:31], v86 offset:512
  ds_read_b128 v[32:35], v86 offset:1024
  ds_read_b128 v[36:39], v86 offset:1536
  s_waitcnt lgkmcnt(2)
  v_add_f32 v24, v24, v28
  v_add_f32 v25, v25, v29
  v_add_f32 v26, v26, v30
  v_add_f32 v27, v27, v31
  s_waitcnt lgkmcnt(0)
  v_add_f32 v32, v32, v36
  v_add_f32 v33, v33, v37
  v_add_f32 v34, v34, v38
  v_add_f32 v35, v35, v39
  v_add_f32 v24, v24, v32
  v_add_f32 v25, v25, v33
  v_add_f32 v26, v26, v34
  v_add_f32 v27, v27, v35
  v_mul_f32 v24, v70, v24
  v_mul_f32 v25, v70, v25
  v_mul_f32 v26, v70, v26
  v_mul_f32 v27, v70, v27
  v_bfi_b32 v24, s3, v6, v24
  v_bfi_b32 v25, s3, v6, v25
  v_bfi_b32 v26, s3, v6, v26
  v_bfi_b32 v27, s3, v6, v27
  s_mov_b32 exec_lo, 0xffffffff
  s_mov_b32 exec_hi, 0x0
  s_cmp_eq_u32 s15, 1
  s_cbranch_scc1 L_ost_29_l
  global_store_dwordx4 v66, v[24:27], s[26:27] sc1
  s_branch L_ost_29_x
L_ost_29_l:
  global_store_dwordx4 v66, v[24:27], s[26:27] sc0
L_ost_29_x:
  s_mov_b64 exec, -1
L_noopub_28:
  s_cmp_ge_u32 s32, 5
  s_cbranch_scc1 L_noproj3_30
  s_mov_b32 s53, 1600000
L_opoll_31:
  global_load_dwordx4 v[32:35], v93, s[26:27] offset:0 sc1
  global_load_dwordx4 v[36:39], v93, s[26:27] offset:1024 sc1
  global_load_dwordx4 v[40:43], v93, s[26:27] offset:2048 sc1
  global_load_dwordx4 v[44:47], v93, s[26:27] offset:3072 sc1
  s_sub_u32 s53, s53, 1
  s_cbranch_scc1 L_opoll_31_x
  s_waitcnt vmcnt(0)
  v_xor_b32 v32, v32, v87
  v_xor_b32 v33, v33, v87
  v_xor_b32 v34, v34, v87
  v_xor_b32 v35, v35, v87
  v_xor_b32 v36, v36, v87
  v_xor_b32 v37, v37, v87
  v_xor_b32 v38, v38, v87
  v_xor_b32 v39, v39, v87
  v_xor_b32 v40, v40, v87
  v_xor_b32 v41, v41, v87
  v_xor_b32 v42, v42, v87
  v_xor_b32 v43, v43, v87
  v_xor_b32 v44, v44, v87
  v_xor_b32 v45, v45, v87
  v_xor_b32 v46, v46, v87
  v_xor_b32 v47, v47, v87
  v_or_b32 v8, v32, v33
  v_or3_b32 v8, v8, v34, v35
  v_or3_b32 v8, v8, v36, v37
  v_or3_b32 v8, v8, v38, v39
  v_or3_b32 v8, v8, v40, v41
  v_or3_b32 v8, v8, v42, v43
  v_or3_b32 v8, v8, v44, v45
  v_or3_b32 v8, v8, v46, v47
  v_and_b32 v8, 0xff, v8
  v_cmp_ne_u32 vcc, 0, v8
  s_nop 0
  s_cbranch_vccnz L_opoll_31
L_opoll_31_x:
  s_waitcnt vmcnt(0)
  v_add_f32 v64, v32, v40
  v_add_f32 v65, v33, v41
  v_add_f32 v66, v34, v42
  v_add_f32 v67, v35, v43
  v_add_f32 v68, v36, v44
  v_add_f32 v69, v37, v45
  v_add_f32 v70, v38, v46
  v_add_f32 v71, v39, v47
  v_cvt_pk_bf16_f32 v64, v64, v65
  v_cvt_pk_bf16_f32 v65, v66, v67
  ds_write_b64 v94, v[64:65] offset:0
  v_cvt_pk_bf16_f32 v68, v68, v69
  v_cvt_pk_bf16_f32 v69, v70, v71
  ds_write_b64 v94, v[68:69] offset:512
  ds_read_b128 v[8:11], v95 offset:0
  ds_read_b128 v[12:15], v95 offset:64
  ds_read_b128 v[16:19], v95 offset:128
  ds_read_b128 v[20:23], v95 offset:192
  s_waitcnt lgkmcnt(3)
  v_mfma_f32_16x16x32_bf16 v[24:27], v[96:99], v[8:11], 0
  s_waitcnt lgkmcnt(2)
  v_mfma_f32_16x16x32_bf16 v[24:27], v[100:103], v[12:15], v[24:27]
  s_waitcnt lgkmcnt(1)
  v_mfma_f32_16x16x32_bf16 v[24:27], v[104:107], v[16:19], v[24:27]
  s_waitcnt lgkmcnt(0)
  v_mfma_f32_16x16x32_bf16 v[24:27], v[108:111], v[20:23], v[24:27]
  v_mfma_f32_16x16x32_bf16 v[28:31], v[112:115], v[8:11], 0
  v_mfma_f32_16x16x32_bf16 v[28:31], v[116:119], v[12:15], v[28:31]
  v_mfma_f32_16x16x32_bf16 v[28:31], v[120:123], v[16:19], v[28:31]
  v_mfma_f32_16x16x32_bf16 v[28:31], v[124:127], v[20:23], v[28:31]
  s_nop 3
  v_bfi_b32 v24, s3, v6, v24
  v_bfi_b32 v25, s3, v6, v25
  v_bfi_b32 v26, s3, v6, v26
  v_bfi_b32 v27, s3, v6, v27
  buffer_store_dwordx4 v[24:27], v82, s[40:43], s48 offen offset:0 sc1
  v_bfi_b32 v28, s3, v6, v28
  v_bfi_b32 v29, s3, v6, v29
  v_bfi_b32 v30, s3, v6, v30
  v_bfi_b32 v31, s3, v6, v31
  buffer_store_dwordx4 v[28:31], v82, s[40:43], s48 offen offset:2048 sc1
L_noproj3_30:
  s_cmp_lg_u32 s35, 3
  s_cbranch_scc1 L_fin
  s_mov_b32 s53, 1600000
L_ypoll_32:
  global_load_dwordx4 v[32:35], v85, s[26:27] offset:0 sc1
  global_load_dwordx4 v[36:39], v85, s[26:27] offset:1024 sc1
  s_sub_u32 s53, s53, 1
  s_cbranch_scc1 L_ypoll_32_x
  s_waitcnt vmcnt(0)
  v_xor_b32 v32, v32, v87
  v_xor_b32 v33, v33, v87
  v_xor_b32 v34, v34, v87
  v_xor_b32 v35, v35, v87
  v_xor_b32 v36, v36, v87
  v_xor_b32 v37, v37, v87
  v_xor_b32 v38, v38, v87
  v_xor_b32 v39, v39, v87
  v_or_b32 v8, v32, v33
  v_or3_b32 v8, v8, v34, v35
  v_or3_b32 v8, v8, v36, v37
  v_or3_b32 v8, v8, v38, v39
  v_and_b32 v8, 0xff, v8
  v_cmp_ne_u32 vcc, 0, v8
  s_nop 0
  s_cbranch_vccnz L_ypoll_32
L_ypoll_32_x:
  s_waitcnt vmcnt(0)
  v_add_f32 v12, v32, v36
  v_add_f32 v13, v33, v37
  v_add_f32 v14, v34, v38
  v_add_f32 v15, v35, v39
  v_add_f32_dpp v12, v12, v12 row_ror:4 row_mask:0xf bank_mask:0xf
  v_add_f32_dpp v13, v13, v13 row_ror:4 row_mask:0xf bank_mask:0xf
  v_add_f32_dpp v14, v14, v14 row_ror:4 row_mask:0xf bank_mask:0xf
  v_add_f32_dpp v15, v15, v15 row_ror:4 row_mask:0xf bank_mask:0xf
  v_add_f32_dpp v12, v12, v12 row_ror:8 row_mask:0xf bank_mask:0xf
  v_add_f32_dpp v13, v13, v13 row_ror:8 row_mask:0xf bank_mask:0xf
  v_add_f32_dpp v14, v14, v14 row_ror:8 row_mask:0xf bank_mask:0xf
  v_add_f32_dpp v15, v15, v15 row_ror:8 row_mask:0xf bank_mask:0xf
  v_mov_b32 v16, v12
  v_mov_b32 v17, v13
  v_mov_b32 v18, v14
  v_mov_b32 v19, v15
  v_permlane16_swap_b32 v16, v12
  v_permlane16_swap_b32 v17, v13
  v_permlane16_swap_b32 v18, v14
  v_permlane16_swap_b32 v19, v15
  v_add_f32 v12, v12, v16
  v_add_f32 v13, v13, v17
  v_add_f32 v14, v14, v18
  v_add_f32 v15, v15, v19
  v_mov_b32 v16, v12
  v_mov_b32 v17, v13
  v_mov_b32 v18, v14
  v_mov_b32 v19, v15
  v_permlane32_swap_b32 v16, v12
  v_permlane32_swap_b32 v17, v13
  v_permlane32_swap_b32 v18, v14
  v_permlane32_swap_b32 v19, v15
  v_add_f32 v12, v12, v16
  v_add_f32 v13, v13, v17
  v_add_f32 v14, v14, v18
  v_add_f32 v15, v15, v19
  v_cvt_pk_bf16_f32 v16, v12, v13
  v_cvt_pk_bf16_f32 v17, v14, v15
  v_lshlrev_b32 v12, 16, v16
  v_and_b32 v13, 0xffff0000, v16
  v_lshlrev_b32 v14, 16, v17
  v_and_b32 v15, 0xffff0000, v17
  v_mul_f32 v12, v12, v74
  v_mul_f32 v13, v13, v75
  v_mul_f32 v14, v14, v76
  v_mul_f32 v15, v15, v77
  v_cvt_pk_bf16_f32 v16, v12, v13
  v_cvt_pk_bf16_f32 v17, v14, v15
  v_lshlrev_b32 v12, 16, v16
  v_and_b32 v13, 0xffff0000, v16
  v_lshlrev_b32 v14, 16, v17
  v_and_b32 v15, 0xffff0000, v17
  v_add_f32 v12, v12, v78
  v_add_f32 v13, v13, v79
  v_add_f32 v14, v14, v80
  v_add_f32 v15, v15, v81
  v_cvt_pk_bf16_f32 v16, v12, v13
  v_cvt_pk_bf16_f32 v17, v14, v15
  s_mov_b64 exec, 0xf
  global_store_dwordx2 v84, v[16:17], s[22:23]
  s_mov_b64 exec, -1
L_fin:
L_exit:
  s_endpgm
.section .rodata,"a"
.p2align 6
.amdhsa_kernel recurrent_scan__gqa_block_cached__geglu_ffn__decode_kernel
  .amdhsa_next_free_vgpr 256
  .amdhsa_next_free_sgpr 96
  .amdhsa_accum_offset 256
  .amdhsa_group_segment_fixed_size 0
  .amdhsa_kernarg_size 96
  .amdhsa_user_sgpr_count 2
  .amdhsa_user_sgpr_kernarg_segment_ptr 1
  .amdhsa_system_sgpr_workgroup_id_x 1
.end_amdhsa_kernel
```
